```python
import torch

def _softmax(x, axis=-1):
    return torch.softmax(x, dim=axis)
def _gelu(x):
    return torch.nn.functional.gelu(x, approximate="tanh")
def _silu(x):
    return torch.nn.functional.silu(x)
def _sigmoid(x):
    return torch.sigmoid(x)
def _layernorm(x, axis=-1, eps=1e-5):
    m = x.mean(dim=axis, keepdim=True)
    v = x.var(dim=axis, keepdim=True, unbiased=False)
    return (x - m) / torch.sqrt(v + eps)
def _scatter_add(tgt, idx, src, axis=0):
    return tgt.clone().index_add_(axis, idx, src)
def _segment_sum(src, seg, n):
    out = torch.zeros((n,) + src.shape[1:], dtype=src.dtype)
    return out.index_add_(0, seg, src)
def _pad(x, pw):
    flat = tuple(v for pair in reversed(pw) for v in pair)
    return torch.nn.functional.pad(x, flat)

kernel_name = 'gated_mix__sliding_block_cached__glu_gated_geglu__decode'

def setup_inputs():

    _w = (lambda a: (lambda t: t.to(torch.bfloat16) if t.is_floating_point() else t)(torch.as_tensor(a)))
    def _A_setup():
        B, Sq, D = 1, 1, 640
        Hq, Hkv, Sk, Dh = 32, 32, 4096, 192
        assert Hq % Hkv == 0, (Hq, Hkv)
        return {
            "x": _w((lambda *s: torch.randn(*s, dtype=torch.bfloat16) * 0.05)(B, Sq, D)),
            "k_cache": _w((lambda *s: torch.randn(*s, dtype=torch.bfloat16) * 6.4)(B, Hkv, Sk, Dh)),
            "v_cache": _w((lambda *s: torch.randn(*s, dtype=torch.bfloat16) * 0.05)(B, Hkv, Sk, Dh)),
            "wq": _w((lambda *s: torch.randn(*s, dtype=torch.bfloat16) * 6.4)(D, Hq * Dh) * (D ** -0.5)),
            "wo": _w((lambda *s: torch.randn(*s, dtype=torch.bfloat16) * 0.05)(Hq * Dh, D) * ((Hq * Dh) ** -0.5)),
        }
    _A_in = _A_setup()

    def _B_setup():
        B, S, Dm, Df = 1, 1, 640, 1536
        return {
            "x": _w((lambda *s: torch.randn(*s, dtype=torch.bfloat16) * 0.05)(B, S, Dm)),
            "w_gate": _w((lambda *s: torch.randn(*s, dtype=torch.bfloat16) * 0.8)(Dm, Df) * (Dm ** -0.5)),
            "w_up": _w((lambda *s: torch.randn(*s, dtype=torch.bfloat16) * 0.8)(Dm, Df) * (Dm ** -0.5)),
            "w_down": _w((lambda *s: torch.randn(*s, dtype=torch.bfloat16) * 0.8)(Df, Dm) * (Df ** -0.5)),
        }
    _B_in = _B_setup()

    return {
        "A_x": _A_in["x"],
        "A_k_cache": _A_in["k_cache"],
        "A_v_cache": _A_in["v_cache"],
        "A_wq": _A_in["wq"],
        "A_wo": _A_in["wo"],
        "B_x": _B_in["x"],
        "B_w_gate": _B_in["w_gate"],
        "B_w_up": _B_in["w_up"],
        "B_w_down": _B_in["w_down"],
        "gate_w": _w((lambda *s: torch.randn(*s, dtype=torch.bfloat16) * 0.05)(640) * 16.0),
    }

def reference(A_x, A_k_cache, A_v_cache, A_wq, A_wo, B_x, B_w_gate, B_w_up, B_w_down, gate_w):
    def _A_ref(x, k_cache, v_cache, wq, wo):
        B, Sq, D = x.shape
        Hq, Dh = 32, 192
        Hkv, Sk = k_cache.shape[1], k_cache.shape[2]
        W = min(4096, max(256, Sk // 4))
        rep = Hq // Hkv
        q = (lambda x, *d: x.permute(*d))((x @ wq).reshape(B, Sq, Hq, Dh), 0, 2, 1, 3)
        k = (lambda x, n, axis: torch.repeat_interleave(x, n, dim=axis))(k_cache[:, :, Sk - W:, :], rep, axis=1)
        v = (lambda x, n, axis: torch.repeat_interleave(x, n, dim=axis))(v_cache[:, :, Sk - W:, :], rep, axis=1)
        scores = torch.einsum("bhqd,bhkd->bhqk", q, k) * (Dh ** -0.5)
        p = _softmax(scores, axis=-1)
        o = torch.einsum("bhqk,bhkd->bhqd", p, v)
        return (lambda x, *d: x.permute(*d))(o, 0, 2, 1, 3).reshape(B, Sq, Hq * Dh) @ wo

    def _B_ref(x, w_gate, w_up, w_down):
        g = torch.einsum("bsd,df->bsf", x, w_gate)
        u = torch.einsum("bsd,df->bsf", x, w_up)
        h = _gelu(g) * u
        return torch.einsum("bsf,fd->bsd", h, w_down)

    x = A_x
    g = _sigmoid((x * gate_w).sum(-1, keepdims=True))
    a = _A_ref(x, A_k_cache, A_v_cache, A_wq, A_wo)
    b = _B_ref(x, B_w_gate, B_w_up, B_w_down)
    return g * a + (1 - g) * b
```

```asm
; @launch grid=(256,1,1) block=(512,1,1) lds=16640
.amdgcn_target "amdgcn-amd-amdhsa--gfx950"
.text
.globl gated_mix__sliding_block_cached__glu_gated_geglu__decode_kernel
.p2align 12
.p2align 8
.type gated_mix__sliding_block_cached__glu_gated_geglu__decode_kernel,@function
gated_mix__sliding_block_cached__glu_gated_geglu__decode_kernel:
    s_load_dwordx16 s[4:19], s[0:1], 0
    s_load_dwordx8 s[20:27], s[0:1], 64
    s_load_dwordx2 s[28:29], s[0:1], 96
    s_cmp_ge_u32 s2, 256
    s_cbranch_scc1 L_exit
    v_lshrrev_b32 v2, 6, v0
    v_and_b32 v1, 63, v0
    s_and_b32 s31, s2, 7
    v_readfirstlane_b32 s30, v2
    s_lshr_b32 s32, s2, 3
    s_lshr_b32 s34, s32, 2
    s_and_b32 s35, s32, 3
    s_lshl_b32 s33, s31, 2
    s_add_u32 s33, s33, s35
    v_mov_b32 v7, 0
    v_mov_b32 v6, 1
    s_cmp_ge_u32 s30, 4
    s_cbranch_scc0 L_pS

    v_lshlrev_b32 v2, 2, v1
    ds_write_b32 v2, v7
    ds_write_b32 v2, v7 offset:256
    s_cmp_eq_u32 s30, 4
    s_cbranch_scc0 L_tw1
    s_cmp_eq_u32 s35, 1
    s_cbranch_scc1 L_tw0r1
    s_cmp_eq_u32 s35, 2
    s_cbranch_scc1 L_tw0r2
    s_call_b64 s[74:75], L_pad0
    s_branch L_tw0j
L_tw0r1:
    s_call_b64 s[74:75], L_pad4
    s_branch L_tw0j
L_tw0r2:
    s_call_b64 s[74:75], L_pad8
L_tw0j:
    s_waitcnt lgkmcnt(0)
    s_load_dword s36, s[28:29], 0
    s_barrier
    s_call_b64 s[74:75], L_pad0
    s_call_b64 s[74:75], L_pad4
    s_call_b64 s[74:75], L_pad8
    s_branch L_helper
L_tw1:
    s_cmp_eq_u32 s30, 5
    s_cbranch_scc0 L_tw2
    s_cmp_eq_u32 s35, 1
    s_cbranch_scc1 L_tw1r1
    s_cmp_eq_u32 s35, 2
    s_cbranch_scc1 L_tw1r2
    s_call_b64 s[74:75], L_pad1
    s_branch L_tw1j
L_tw1r1:
    s_call_b64 s[74:75], L_pad5
    s_branch L_tw1j
L_tw1r2:
    s_call_b64 s[74:75], L_pad9
L_tw1j:
    s_waitcnt lgkmcnt(0)
    s_load_dword s36, s[28:29], 0
    s_barrier
    s_call_b64 s[74:75], L_pad1
    s_call_b64 s[74:75], L_pad5
    s_call_b64 s[74:75], L_pad9
    s_branch L_helper
L_tw2:
    s_cmp_eq_u32 s30, 6
    s_cbranch_scc0 L_tw3
    s_cmp_eq_u32 s35, 1
    s_cbranch_scc1 L_tw2r1
    s_cmp_eq_u32 s35, 2
    s_cbranch_scc1 L_tw2r2
    s_call_b64 s[74:75], L_pad2
    s_branch L_tw2j
L_tw2r1:
    s_call_b64 s[74:75], L_pad6
    s_branch L_tw2j
L_tw2r2:
    s_call_b64 s[74:75], L_pad10
L_tw2j:
    s_waitcnt lgkmcnt(0)
    s_load_dword s36, s[28:29], 0
    s_barrier
    s_call_b64 s[74:75], L_pad2
    s_call_b64 s[74:75], L_pad6
    s_call_b64 s[74:75], L_pad10
    s_branch L_helper
L_tw3:
    s_cmp_eq_u32 s35, 1
    s_cbranch_scc1 L_tw3r1
    s_call_b64 s[74:75], L_pad3
    s_branch L_tw3j
L_tw3r1:
    s_call_b64 s[74:75], L_pad7
L_tw3j:
    s_waitcnt lgkmcnt(0)
    s_load_dword s36, s[28:29], 0
    s_barrier
    s_call_b64 s[74:75], L_pad3
    s_call_b64 s[74:75], L_pad7
    s_branch L_helper

L_pS:

    s_lshl_b32 s37, s34, 2
    s_add_u32 s37, s37, s30
    s_movk_i32 s43, 12288
    s_mul_i32 s45, s33, 384
    s_mov_b32 s42, 1
    s_mov_b32 s38, 2
    s_cmp_eq_u32 s34, 7
    s_cbranch_scc1 L_pF
    s_mul_i32 s44, s37, 36
    s_mul_i32 s62, s37, 24
    s_cmp_eq_u32 s34, 6
    s_cbranch_scc0 L_pC
    s_mov_b32 s42, 2
    s_mul_i32 s44, s30, 40
    s_add_u32 s44, s44, 864
    s_lshl_b32 s62, s30, 4
    s_add_u32 s62, s62, 576
    s_branch L_pC
L_pF:
    s_mov_b32 s42, 0
    s_movk_i32 s43, 3072
    s_mul_i32 s45, s31, 384
    s_lshl_b32 s37, s35, 2
    s_add_u32 s37, s37, s30
    s_mul_i32 s62, s37, 40
    s_mov_b32 s38, 4
L_pC:
    v_lshrrev_b32 v4, 3, v1
    v_mul_u32_u24 v3, s38, v4
    v_add_u32 v3, s62, v3
    v_mul_u32_u24 v2, s43, v3
    v_lshlrev_b32 v3, 1, v3
    v_and_b32 v5, 7, v1
    v_lshlrev_b32 v5, 4, v5
    v_add3_u32 v2, v2, v5, s45
    s_lshl_b32 s38, s38, 3
    s_add_u32 s37, s62, s38
    v_add_u32 v19, s37, v4
    v_mul_u32_u24 v23, s43, v19
    v_add3_u32 v23, v23, v5, s45
    v_lshlrev_b32 v19, 1, v19
    v_mov_b32 v21, s43
    s_cmp_eq_u32 s42, 0
    s_cselect_b32 exec_hi, 0, -1
    s_mov_b32 exec_lo, 0
    v_add_u32 v2, s43, v2
    v_sub_u32 v21, 0, v21
    s_mov_b64 exec, -1
    s_cmp_eq_u32 s42, 0
    s_waitcnt lgkmcnt(0)
    s_cselect_b64 s[40:41], s[16:17], s[10:11]
    global_load_dword v16, v3, s[4:5]
    global_load_dwordx4 v[64:67], v2, s[40:41] offset:0 nt
    global_load_dwordx4 v[68:71], v2, s[40:41] offset:128 nt
    global_load_dwordx4 v[72:75], v2, s[40:41] offset:256 nt
    v_add_u32 v2, v21, v2
    global_load_dwordx4 v[76:79], v2, s[40:41] offset:0 nt
    global_load_dwordx4 v[80:83], v2, s[40:41] offset:128 nt
    global_load_dwordx4 v[84:87], v2, s[40:41] offset:256 nt
    v_add_u32 v2, v21, v2
    s_cmp_eq_u32 s42, 0
    s_cbranch_scc1 L_F
    s_mul_i32 s37, s33, 1572864
    s_mul_i32 s38, s44, 384
    s_add_u32 s37, s37, s38
    s_add_u32 s37, s37, 1182720
    v_mul_u32_u24 v20, 384, v4
    v_add3_u32 v20, v20, v5, s37
    v_add_u32 v21, 9216, v20
    s_cmp_eq_u32 s42, 2
    s_cbranch_scc1 L_T2
    global_load_ushort v18, v19, s[4:5]
    global_load_dwordx4 v[92:95], v23, s[10:11] offset:0 nt
    global_load_dwordx4 v[96:99], v23, s[10:11] offset:128 nt
    global_load_dwordx4 v[100:103], v23, s[10:11] offset:256 nt
    s_mov_b32 s63, 0
    s_load_dword s36, s[28:29], 0
    s_barrier
    s_branch L_blk
    .p2align 10
L_pad0:
    s_setpc_b64 s[74:75]
L_blk:
    v_and_b32 v24, 1, v1
    v_cmp_eq_u32 vcc, 1, v24
    v_mov_b32 v8, 0x0c0c0100
    v_mov_b32 v9, 0x01000c0c
    v_cndmask_b32 v24, v8, v9, vcc
    v_mov_b32 v8, 0x0c0c0302
    v_mov_b32 v9, 0x03020c0c
    v_cndmask_b32 v25, v8, v9, vcc
    v_bfe_u32 v26, v1, 1, 2
    v_mov_b32 v27, 0x0c0c0c0c
    v_cmp_eq_u32 vcc, 0, v26
    s_nop 1
    v_cndmask_b32 v8, v27, v24, vcc
    v_cndmask_b32 v12, v27, v25, vcc
    v_cmp_eq_u32 vcc, 1, v26
    s_nop 1
    v_cndmask_b32 v9, v27, v24, vcc
    v_cndmask_b32 v13, v27, v25, vcc
    v_cmp_eq_u32 vcc, 2, v26
    s_nop 1
    v_cndmask_b32 v10, v27, v24, vcc
    v_cndmask_b32 v14, v27, v25, vcc
    v_cmp_eq_u32 vcc, 3, v26
    s_nop 1
    v_cndmask_b32 v11, v27, v24, vcc
    v_cndmask_b32 v15, v27, v25, vcc
    v_lshrrev_b32 v22, 5, v1
    s_lshl_b32 s37, s30, 1
    v_add_u32 v22, s37, v22
    v_mul_u32_u24 v22, 784, v22
    v_lshl_add_u32 v22, v5, 1, v22
    v_and_b32 v3, 16, v1
    v_add_u32 v22, v22, v3
    v_mov_b32 v56, 0
    v_mov_b32 v57, 0
    v_mov_b32 v58, 0
    v_mov_b32 v59, 0
    v_mov_b32 v60, 0
    v_mov_b32 v212, 0
    v_mov_b32 v213, 0
    v_mov_b32 v214, 0
    v_mov_b32 v215, 0
    v_mov_b32 v216, 0
    v_mov_b32 v217, 0
    v_mov_b32 v218, 0
    v_mov_b32 v219, 0
    v_mov_b32 v220, 0
    v_mov_b32 v221, 0
    v_mov_b32 v222, 0
    v_mov_b32 v223, 0
    s_add_u32 s64, s28, 2097152
    s_addc_u32 s65, s29, 0
    s_getreg_b32 s70, hwreg(HW_REG_XCC_ID, 0, 4)
    s_lshl_b32 s70, s70, 24
    s_mov_b32 s46, 0x0c0c0400
    s_mov_b32 s47, 0x05040100
    s_waitcnt vmcnt(10)
    s_mov_b32 exec_lo, 0
    v_alignbit_b32 v16, v16, v16, 16
    s_mov_b32 exec_lo, -1
    v_perm_b32 v24, v16, v16, v8
    v_perm_b32 v25, v16, v16, v9
    v_perm_b32 v26, v16, v16, v10
    v_perm_b32 v27, v16, v16, v11
    s_waitcnt vmcnt(9)
    s_nop 0
    v_mfma_f32_16x16x32_bf16 v[32:35], v[24:27], v[64:67], 0
    global_load_dwordx4 v[104:107], v20, s[6:7] offset:-3072 nt
    s_waitcnt vmcnt(9)
    v_mfma_f32_16x16x32_bf16 v[36:39], v[24:27], v[68:71], 0
    s_waitcnt vmcnt(8)
    v_mfma_f32_16x16x32_bf16 v[40:43], v[24:27], v[72:75], 0
    v_perm_b32 v28, v16, v16, v12
    v_perm_b32 v29, v16, v16, v13
    v_perm_b32 v30, v16, v16, v14
    v_perm_b32 v31, v16, v16, v15
    s_waitcnt vmcnt(7)
    s_nop 0
    v_mfma_f32_16x16x32_bf16 v[32:35], v[28:31], v[76:79], v[32:35]
    s_waitcnt vmcnt(6)
    v_mfma_f32_16x16x32_bf16 v[36:39], v[28:31], v[80:83], v[36:39]
    s_waitcnt vmcnt(5)
    v_mfma_f32_16x16x32_bf16 v[40:43], v[28:31], v[84:87], v[40:43]
    global_load_dwordx4 v[108:111], v20, s[6:7] offset:-2944 nt
    s_waitcnt vmcnt(5)
    v_perm_b32 v24, v18, v18, v8
    v_perm_b32 v25, v18, v18, v9
    v_perm_b32 v26, v18, v18, v10
    v_perm_b32 v27, v18, v18, v11
    s_waitcnt vmcnt(4)
    s_nop 0
    v_mfma_f32_16x16x32_bf16 v[32:35], v[24:27], v[92:95], v[32:35]
    global_load_dwordx4 v[112:115], v20, s[6:7] offset:-2816 nt
    global_load_dwordx4 v[116:119], v20, s[6:7] offset:0 nt
    s_waitcnt vmcnt(5)
    v_mfma_f32_16x16x32_bf16 v[36:39], v[24:27], v[96:99], v[36:39]
    global_load_dwordx4 v[120:123], v20, s[6:7] offset:128 nt
    s_waitcnt vmcnt(5)
    v_mfma_f32_16x16x32_bf16 v[40:43], v[24:27], v[100:103], v[40:43]
    s_mov_b32 exec_lo, 0xff00ff
    s_mov_b32 exec_hi, 0xff00ff00
    s_nop 3
    ds_write_b128 v22, v[32:35] offset:512
    ds_write_b128 v22, v[36:39] offset:768
    ds_write_b128 v22, v[40:43] offset:1024
    s_mov_b64 exec, 1
    ds_add_u32 v7, v6 offset:0
    s_mov_b64 exec, -1
    global_load_dwordx4 v[124:127], v20, s[6:7] offset:256 nt
    s_waitcnt vmcnt(5)
    global_load_dwordx4 v[128:131], v20, s[6:7] offset:3072 nt
    s_waitcnt vmcnt(5)
    global_load_dwordx4 v[132:135], v20, s[6:7] offset:3200 nt
    s_branch L_Tjoin
L_T2:
    s_mov_b32 s63, -1
    global_load_dwordx4 v[104:107], v20, s[6:7] offset:-3072 nt
    global_load_dwordx4 v[108:111], v20, s[6:7] offset:-2944 nt
    global_load_dwordx4 v[112:115], v20, s[6:7] offset:-2816 nt
    global_load_dwordx4 v[116:119], v20, s[6:7] offset:0 nt
    s_load_dword s36, s[28:29], 0
    s_barrier
    v_and_b32 v24, 1, v1
    v_cmp_eq_u32 vcc, 1, v24
    v_mov_b32 v8, 0x0c0c0100
    v_mov_b32 v9, 0x01000c0c
    v_cndmask_b32 v24, v8, v9, vcc
    v_mov_b32 v8, 0x0c0c0302
    v_mov_b32 v9, 0x03020c0c
    v_cndmask_b32 v25, v8, v9, vcc
    v_bfe_u32 v26, v1, 1, 2
    v_mov_b32 v27, 0x0c0c0c0c
    v_cmp_eq_u32 vcc, 0, v26
    s_nop 1
    v_cndmask_b32 v8, v27, v24, vcc
    v_cndmask_b32 v12, v27, v25, vcc
    v_cmp_eq_u32 vcc, 1, v26
    s_nop 1
    v_cndmask_b32 v9, v27, v24, vcc
    v_cndmask_b32 v13, v27, v25, vcc
    v_cmp_eq_u32 vcc, 2, v26
    s_nop 1
    v_cndmask_b32 v10, v27, v24, vcc
    v_cndmask_b32 v14, v27, v25, vcc
    v_cmp_eq_u32 vcc, 3, v26
    s_nop 1
    v_cndmask_b32 v11, v27, v24, vcc
    v_cndmask_b32 v15, v27, v25, vcc
    v_lshrrev_b32 v22, 5, v1
    s_lshl_b32 s37, s30, 1
    v_add_u32 v22, s37, v22
    v_mul_u32_u24 v22, 784, v22
    v_lshl_add_u32 v22, v5, 1, v22
    v_and_b32 v3, 16, v1
    v_add_u32 v22, v22, v3
    v_mov_b32 v56, 0
    v_mov_b32 v57, 0
    v_mov_b32 v58, 0
    v_mov_b32 v59, 0
    v_mov_b32 v60, 0
    s_add_u32 s64, s28, 2097152
    s_addc_u32 s65, s29, 0
    s_getreg_b32 s70, hwreg(HW_REG_XCC_ID, 0, 4)
    s_lshl_b32 s70, s70, 24
    s_mov_b32 s46, 0x0c0c0400
    s_mov_b32 s47, 0x05040100
    s_waitcnt vmcnt(10)
    s_mov_b32 exec_lo, 0
    v_alignbit_b32 v16, v16, v16, 16
    s_mov_b32 exec_lo, -1
    v_perm_b32 v24, v16, v16, v8
    v_perm_b32 v25, v16, v16, v9
    v_perm_b32 v26, v16, v16, v10
    v_perm_b32 v27, v16, v16, v11
    s_waitcnt vmcnt(9)
    s_nop 0
    v_mfma_f32_16x16x32_bf16 v[32:35], v[24:27], v[64:67], 0
    global_load_dwordx4 v[120:123], v20, s[6:7] offset:128 nt
    s_waitcnt vmcnt(9)
    v_mfma_f32_16x16x32_bf16 v[36:39], v[24:27], v[68:71], 0
    s_waitcnt vmcnt(8)
    v_mfma_f32_16x16x32_bf16 v[40:43], v[24:27], v[72:75], 0
    v_perm_b32 v28, v16, v16, v12
    s_branch L_pads1
L_pad1:
    s_setpc_b64 s[74:75]
L_pads1:
    v_perm_b32 v29, v16, v16, v13
    v_perm_b32 v30, v16, v16, v14
    v_perm_b32 v31, v16, v16, v15
    s_waitcnt vmcnt(7)
    s_nop 0
    v_mfma_f32_16x16x32_bf16 v[32:35], v[28:31], v[76:79], v[32:35]
    s_waitcnt vmcnt(6)
    v_mfma_f32_16x16x32_bf16 v[36:39], v[28:31], v[80:83], v[36:39]
    s_waitcnt vmcnt(5)
    v_mfma_f32_16x16x32_bf16 v[40:43], v[28:31], v[84:87], v[40:43]
    s_mov_b32 exec_lo, 0xff00ff
    s_mov_b32 exec_hi, 0xff00ff00
    s_nop 3
    ds_write_b128 v22, v[32:35] offset:512
    ds_write_b128 v22, v[36:39] offset:768
    ds_write_b128 v22, v[40:43] offset:1024
    s_mov_b64 exec, 1
    ds_add_u32 v7, v6 offset:0
    s_mov_b64 exec, -1
    global_load_dwordx4 v[124:127], v20, s[6:7] offset:256 nt
    s_waitcnt vmcnt(5)
    global_load_dwordx4 v[128:131], v20, s[6:7] offset:3072 nt
    s_waitcnt vmcnt(5)
    global_load_dwordx4 v[132:135], v20, s[6:7] offset:3200 nt
L_Tjoin:
    s_cmp_lt_u32 s35, 1
    s_cselect_b64 vcc, -1, 0
    s_cbranch_vccnz L_nw1
    s_waitcnt vmcnt(5)
L_nw1:
    global_load_dwordx4 v[136:139], v20, s[6:7] offset:3328 nt
    s_waitcnt lgkmcnt(0)
    s_add_u32 s36, s36, 0x01010101
    s_xor_b32 s70, s70, s36
    v_mov_b32 v91, s70
    v_and_b32 v88, 0xff, v91
    v_bfe_u32 v89, v91, 8, 8
    v_bfe_u32 v90, v91, 16, 8
    v_lshrrev_b32 v91, 24, v91
    v_mov_b32 v92, 0xffffff00
    s_lshl_b32 s37, s33, 3
    s_add_u32 s37, s37, s34
    s_lshl_b32 s37, s37, 10
    s_add_u32 s37, s37, 327680
    v_lshlrev_b32 v94, 4, v1
    v_add_u32 v93, s37, v94
    s_not_b32 s75, s63
    s_mov_b32 s74, 0
    v_mov_b32 v95, 0xff800000
    s_mul_i32 s37, s30, 1568
    v_mov_b32 v23, s37
    v_mov_b32 v96, 0
    v_mov_b32 v97, 0
    v_mov_b32 v98, 0
    v_mov_b32 v99, 0
    v_mov_b32 v100, 0x80000000
    s_cmp_eq_u32 s30, 0
    s_cselect_b32 s44, -1, 0
    s_mov_b64 exec, 1
    ds_write_b128 v23, v[96:99] offset:2064
    s_mov_b64 exec, -1
    s_mov_b32 s48, 0x3d93cd3a
    s_mov_b32 s49, 0x3fb8aa3b
    s_waitcnt vmcnt(6)
    s_cbranch_vccnz L_nw2
    s_waitcnt vmcnt(5)
L_nw2:
    global_load_dwordx4 v[140:143], v21, s[6:7] offset:-3072 nt
    s_mov_b64 exec, 1
    ds_add_u32 v7, v6 offset:24
    s_mov_b64 exec, -1
    s_waitcnt vmcnt(6)
    s_cbranch_vccnz L_nw3
    s_waitcnt vmcnt(5)
L_nw3:
    global_load_dwordx4 v[144:147], v21, s[6:7] offset:-2944 nt
    s_waitcnt vmcnt(6)
    s_cbranch_vccnz L_nw4
    s_waitcnt vmcnt(5)
L_nw4:
    global_load_dwordx4 v[148:151], v21, s[6:7] offset:-2816 nt
    s_waitcnt vmcnt(6)
    s_cbranch_vccnz L_nw5
    s_waitcnt vmcnt(5)
L_nw5:
    s_mov_b32 exec_hi, s63
    global_load_dwordx4 v[152:155], v21, s[6:7] offset:0 nt
    s_mov_b32 exec_hi, -1
    s_waitcnt vmcnt(6)
    s_cbranch_vccnz L_nw6
    s_waitcnt vmcnt(5)
L_nw6:
    s_mov_b32 exec_hi, s63
    global_load_dwordx4 v[156:159], v21, s[6:7] offset:128 nt
    s_mov_b32 exec_hi, -1
    s_waitcnt vmcnt(6)
    s_cbranch_vccnz L_nw7
    s_waitcnt vmcnt(5)
L_nw7:
    s_mov_b32 exec_hi, s63
    global_load_dwordx4 v[160:163], v21, s[6:7] offset:256 nt
    s_mov_b32 exec_hi, -1
    s_waitcnt vmcnt(6)
    s_cbranch_vccnz L_nw8
    s_waitcnt vmcnt(5)
L_nw8:
    global_load_dwordx4 v[164:167], v20, s[8:9] offset:-3072 nt
    s_waitcnt vmcnt(6)
    s_cbranch_vccnz L_nw9
    s_waitcnt vmcnt(5)
L_nw9:
    global_load_dwordx4 v[168:171], v20, s[8:9] offset:-2944 nt
    s_waitcnt vmcnt(6)
    s_cbranch_vccnz L_nw10
    s_waitcnt vmcnt(5)
L_nw10:
    global_load_dwordx4 v[172:175], v20, s[8:9] offset:-2816 nt
    s_waitcnt vmcnt(6)
    s_cbranch_vccnz L_nw11
    s_waitcnt vmcnt(5)
L_nw11:
    global_load_dwordx4 v[176:179], v20, s[8:9] offset:0 nt
    s_cmp_lt_u32 s35, 3
    s_cselect_b64 vcc, -1, 0
    s_waitcnt vmcnt(6)
    s_cbranch_vccnz L_nw12
    s_waitcnt vmcnt(5)
L_nw12:
    global_load_dwordx4 v[180:183], v20, s[8:9] offset:128 nt
    s_waitcnt vmcnt(6)
    s_cbranch_vccnz L_nw13
    s_waitcnt vmcnt(5)
L_nw13:
    global_load_dwordx4 v[184:187], v20, s[8:9] offset:256 nt
    s_waitcnt vmcnt(6)
    s_cbranch_vccnz L_nw14
    s_waitcnt vmcnt(5)
L_nw14:
    global_load_dwordx4 v[188:191], v20, s[8:9] offset:3072 nt
    s_waitcnt vmcnt(6)
    s_cbranch_vccnz L_nw15
    s_waitcnt vmcnt(5)
L_nw15:
    global_load_dwordx4 v[192:195], v20, s[8:9] offset:3200 nt
    s_waitcnt vmcnt(6)
    s_cbranch_vccnz L_nw16
    s_waitcnt vmcnt(5)
L_nw16:
    global_load_dwordx4 v[196:199], v20, s[8:9] offset:3328 nt
    s_mov_b64 exec, 1
    ds_add_u32 v7, v6 offset:28
    s_mov_b64 exec, -1
    s_mov_b32 s39, 0
    ds_read_b32 v24, v7 offset:4
    ds_read_b128 v[44:47], v5 offset:64
    ds_read_b128 v[48:51], v5 offset:192
    ds_read_b128 v[52:55], v5 offset:320
    s_waitcnt vmcnt(6)
    s_cbranch_vccnz L_nw20
    s_waitcnt vmcnt(5)
L_nw20:
    global_load_dwordx4 v[200:203], v21, s[8:9] offset:-3072 nt
    s_waitcnt lgkmcnt(0)
    v_readfirstlane_b32 s61, v24
    s_cmp_ge_u32 s61, 4
    s_cbranch_scc1 L_spd18
L_sp17:
    ds_read_b32 v24, v7 offset:4
    ds_read_b128 v[44:47], v5 offset:64
    ds_read_b128 v[48:51], v5 offset:192
    ds_read_b128 v[52:55], v5 offset:320
    s_add_u32 s39, s39, 1
    s_waitcnt lgkmcnt(0)
    v_readfirstlane_b32 s61, v24
    s_cmp_ge_u32 s61, 4
    s_cbranch_scc1 L_spd18
    s_sleep 1
    s_cmp_lt_u32 s39, 0x9c400
    s_cbranch_scc1 L_sp17
L_spd18:
    v_dot2c_f32_bf16 v56, v104, v44
    v_dot2c_f32_bf16 v57, v116, v44
    v_dot2c_f32_bf16 v58, v128, v44
    v_dot2c_f32_bf16 v59, v140, v44
    v_dot2c_f32_bf16 v60, v152, v44
    v_dot2c_f32_bf16 v56, v105, v45
    v_dot2c_f32_bf16 v57, v117, v45
    v_dot2c_f32_bf16 v58, v129, v45
    v_dot2c_f32_bf16 v59, v141, v45
    v_dot2c_f32_bf16 v60, v153, v45
    v_dot2c_f32_bf16 v56, v106, v46
    v_dot2c_f32_bf16 v57, v118, v46
    v_dot2c_f32_bf16 v58, v130, v46
    v_dot2c_f32_bf16 v59, v142, v46
    v_dot2c_f32_bf16 v60, v154, v46
    v_dot2c_f32_bf16 v56, v107, v47
    v_dot2c_f32_bf16 v57, v119, v47
    v_dot2c_f32_bf16 v58, v131, v47
    v_dot2c_f32_bf16 v59, v143, v47
    v_dot2c_f32_bf16 v60, v155, v47
    s_waitcnt vmcnt(6)
    s_cbranch_vccnz L_nw21
    s_waitcnt vmcnt(5)
L_nw21:
    global_load_dwordx4 v[204:207], v21, s[8:9] offset:-2944 nt
    v_dot2c_f32_bf16 v56, v108, v48
    v_dot2c_f32_bf16 v57, v120, v48
    v_dot2c_f32_bf16 v58, v132, v48
    v_dot2c_f32_bf16 v59, v144, v48
    v_dot2c_f32_bf16 v60, v156, v48
    v_dot2c_f32_bf16 v56, v109, v49
    v_dot2c_f32_bf16 v57, v121, v49
    v_dot2c_f32_bf16 v58, v133, v49
    v_dot2c_f32_bf16 v59, v145, v49
    v_dot2c_f32_bf16 v60, v157, v49
    v_dot2c_f32_bf16 v56, v110, v50
    v_dot2c_f32_bf16 v57, v122, v50
    v_dot2c_f32_bf16 v58, v134, v50
    s_branch L_pads2
L_pad2:
    s_setpc_b64 s[74:75]
L_pads2:
    v_dot2c_f32_bf16 v59, v146, v50
    v_dot2c_f32_bf16 v60, v158, v50
    v_dot2c_f32_bf16 v56, v111, v51
    v_dot2c_f32_bf16 v57, v123, v51
    v_dot2c_f32_bf16 v58, v135, v51
    v_dot2c_f32_bf16 v59, v147, v51
    v_dot2c_f32_bf16 v60, v159, v51
    s_waitcnt vmcnt(6)
    s_cbranch_vccnz L_nw22
    s_waitcnt vmcnt(5)
L_nw22:
    global_load_dwordx4 v[208:211], v21, s[8:9] offset:-2816 nt
    v_dot2c_f32_bf16 v56, v112, v52
    v_dot2c_f32_bf16 v57, v124, v52
    v_dot2c_f32_bf16 v58, v136, v52
    v_dot2c_f32_bf16 v59, v148, v52
    v_dot2c_f32_bf16 v60, v160, v52
    v_dot2c_f32_bf16 v56, v113, v53
    v_dot2c_f32_bf16 v57, v125, v53
    v_dot2c_f32_bf16 v58, v137, v53
    v_dot2c_f32_bf16 v59, v149, v53
    v_dot2c_f32_bf16 v60, v161, v53
    v_dot2c_f32_bf16 v56, v114, v54
    v_dot2c_f32_bf16 v57, v126, v54
    v_dot2c_f32_bf16 v58, v138, v54
    v_dot2c_f32_bf16 v59, v150, v54
    v_dot2c_f32_bf16 v60, v162, v54
    v_dot2c_f32_bf16 v56, v115, v55
    v_dot2c_f32_bf16 v57, v127, v55
    v_dot2c_f32_bf16 v58, v139, v55
    v_dot2c_f32_bf16 v59, v151, v55
    v_dot2c_f32_bf16 v60, v163, v55
    s_waitcnt vmcnt(6)
    s_cbranch_vccnz L_nw23
    s_waitcnt vmcnt(5)
L_nw23:
    s_mov_b32 exec_hi, s63
    global_load_dwordx4 v[212:215], v21, s[8:9] offset:0 nt
    s_mov_b32 exec_hi, -1
    v_add_f32_dpp v56, v56, v56 quad_perm:[1,0,3,2] row_mask:0xf bank_mask:0xf
    v_add_f32_dpp v57, v57, v57 quad_perm:[1,0,3,2] row_mask:0xf bank_mask:0xf
    v_add_f32_dpp v58, v58, v58 quad_perm:[1,0,3,2] row_mask:0xf bank_mask:0xf
    v_add_f32_dpp v59, v59, v59 quad_perm:[1,0,3,2] row_mask:0xf bank_mask:0xf
    v_add_f32_dpp v60, v60, v60 quad_perm:[1,0,3,2] row_mask:0xf bank_mask:0xf
    v_add_f32_dpp v56, v56, v56 quad_perm:[2,3,0,1] row_mask:0xf bank_mask:0xf
    v_add_f32_dpp v57, v57, v57 quad_perm:[2,3,0,1] row_mask:0xf bank_mask:0xf
    v_add_f32_dpp v58, v58, v58 quad_perm:[2,3,0,1] row_mask:0xf bank_mask:0xf
    v_add_f32_dpp v59, v59, v59 quad_perm:[2,3,0,1] row_mask:0xf bank_mask:0xf
    v_add_f32_dpp v60, v60, v60 quad_perm:[2,3,0,1] row_mask:0xf bank_mask:0xf
    v_add_f32_dpp v56, v56, v56 row_half_mirror row_mask:0xf bank_mask:0xf
    v_add_f32_dpp v57, v57, v57 row_half_mirror row_mask:0xf bank_mask:0xf
    v_add_f32_dpp v58, v58, v58 row_half_mirror row_mask:0xf bank_mask:0xf
    v_add_f32_dpp v59, v59, v59 row_half_mirror row_mask:0xf bank_mask:0xf
    v_add_f32_dpp v60, v60, v60 row_half_mirror row_mask:0xf bank_mask:0xf
    s_waitcnt vmcnt(6)
    s_cbranch_vccnz L_nw24
    s_waitcnt vmcnt(5)
L_nw24:
    s_mov_b32 exec_hi, s63
    global_load_dwordx4 v[216:219], v21, s[8:9] offset:128 nt
    s_mov_b32 exec_hi, -1
    v_cvt_pk_bf16_f32 v24, v56, v57
    v_cvt_pk_bf16_f32 v25, v58, v59
    v_cvt_pk_bf16_f32 v26, v60, v60
    v_lshlrev_b32 v56, 16, v24
    v_and_b32 v57, 0xffff0000, v24
    v_lshlrev_b32 v58, 16, v25
    v_and_b32 v59, 0xffff0000, v25
    v_lshlrev_b32 v60, 16, v26
    v_mul_f32 v56, s48, v56
    v_mul_f32 v57, s48, v57
    v_mul_f32 v58, s48, v58
    v_mul_f32 v59, s48, v59
    v_mul_f32 v60, s48, v60
    v_cvt_pk_bf16_f32 v24, v56, v57
    v_cvt_pk_bf16_f32 v25, v58, v59
    v_cvt_pk_bf16_f32 v26, v60, v60
    v_lshlrev_b32 v56, 16, v24
    v_and_b32 v57, 0xffff0000, v24
    v_lshlrev_b32 v58, 16, v25
    v_and_b32 v59, 0xffff0000, v25
    v_lshlrev_b32 v60, 16, v26
    v_max3_f32 v28, v56, v57, v58
    v_cndmask_b32 v60, v60, v95, s[74:75]
    v_max3_f32 v28, v28, v59, v60
    s_mov_b32 exec_lo, 0x01010101
    s_mov_b32 exec_hi, 0x01010101
    v_ashrrev_i32 v29, 31, v28
    v_bitop3_b32 v28, v28, v29, v100 bitop3:0x1e
    ds_max_u32 v7, v28 offset:32
    s_mov_b64 exec, 1
    ds_add_u32 v7, v6 offset:8
    s_mov_b64 exec, -1
    s_waitcnt vmcnt(6)
    s_cbranch_vccnz L_nw25
    s_waitcnt vmcnt(5)
L_nw25:
    s_mov_b32 exec_hi, s63
    global_load_dwordx4 v[220:223], v21, s[8:9] offset:256 nt
    s_mov_b32 exec_hi, -1
    s_mov_b64 exec, 1
    ds_add_u32 v7, v6 offset:12
    s_mov_b64 exec, -1
    s_mov_b32 s39, 0
L_sp26:
    ds_read_b32 v24, v7 offset:8
    ds_read_b32 v62, v7 offset:32
    s_add_u32 s39, s39, 1
    s_waitcnt lgkmcnt(0)
    v_readfirstlane_b32 s61, v24
    s_cmp_ge_u32 s61, 4
    s_cbranch_scc1 L_spd27
    s_cmp_lt_u32 s39, 0x9c400
    s_cbranch_scc1 L_sp26
L_spd27:
    v_ashrrev_i32 v29, 31, v62
    v_bitop3_b32 v62, v62, v29, v100 bitop3:0x4b
    v_mul_f32 v28, s49, v62
    v_and_b32 v96, s44, v62
    v_fma_f32 v56, v56, s49, -v28
    v_fma_f32 v57, v57, s49, -v28
    v_fma_f32 v58, v58, s49, -v28
    v_fma_f32 v59, v59, s49, -v28
    v_fma_f32 v60, v60, s49, -v28
    v_exp_f32 v56, v56
    v_exp_f32 v57, v57
    v_exp_f32 v58, v58
    v_exp_f32 v59, v59
    v_exp_f32 v60, v60
    s_nop 0
    v_cvt_pk_bf16_f32 v24, v56, v57
    v_cvt_pk_bf16_f32 v25, v58, v59
    v_cvt_pk_bf16_f32 v26, v60, v60
    v_add_f32 v29, v56, v57
    v_add_f32 v30, v58, v59
    v_add_f32 v29, v29, v60
    v_add_f32 v29, v29, v30
    v_perm_b32 v64, v24, v24, v8
    v_perm_b32 v65, v24, v24, v9
    v_perm_b32 v66, v24, v24, v10
    v_perm_b32 v67, v24, v24, v11
    v_add_f32_dpp v29, v29, v29 row_ror:8 row_mask:0xf bank_mask:0xf
    v_mov_b32 v30, v29
    v_perm_b32 v68, v24, v24, v12
    v_perm_b32 v69, v24, v24, v13
    v_perm_b32 v70, v24, v24, v14
    v_perm_b32 v71, v24, v24, v15
    v_permlane16_swap_b32 v29, v30
    s_nop 1
    v_add_f32 v29, v29, v30
    v_mov_b32 v30, v29
    v_perm_b32 v72, v25, v25, v8
    v_perm_b32 v73, v25, v25, v9
    v_perm_b32 v74, v25, v25, v10
    v_perm_b32 v75, v25, v25, v11
    v_permlane32_swap_b32 v29, v30
    v_perm_b32 v76, v25, v25, v12
    v_perm_b32 v77, v25, v25, v13
    v_perm_b32 v78, v25, v25, v14
    v_perm_b32 v79, v25, v25, v15
    v_add_f32 v97, v29, v30
    v_perm_b32 v80, v26, v26, v8
    v_perm_b32 v81, v26, v26, v9
    v_perm_b32 v82, v26, v26, v10
    v_perm_b32 v83, v26, v26, v11
    s_mov_b64 exec, 1
    ds_write_b128 v23, v[96:99] offset:1280
    s_mov_b64 exec, -1
    s_branch L_pads3
    .p2align 10
L_pad3:
    s_setpc_b64 s[74:75]
L_pads3:
    v_mfma_f32_16x16x32_bf16 v[32:35], v[64:67], v[164:167], 0
    v_mfma_f32_16x16x32_bf16 v[36:39], v[64:67], v[168:171], 0
    v_mfma_f32_16x16x32_bf16 v[40:43], v[64:67], v[172:175], 0
    v_mfma_f32_16x16x32_bf16 v[32:35], v[68:71], v[176:179], v[32:35]
    v_mfma_f32_16x16x32_bf16 v[36:39], v[68:71], v[180:183], v[36:39]
    v_mfma_f32_16x16x32_bf16 v[40:43], v[68:71], v[184:187], v[40:43]
    v_mfma_f32_16x16x32_bf16 v[32:35], v[72:75], v[188:191], v[32:35]
    v_mfma_f32_16x16x32_bf16 v[36:39], v[72:75], v[192:195], v[36:39]
    s_waitcnt vmcnt(6)
    v_mfma_f32_16x16x32_bf16 v[40:43], v[72:75], v[196:199], v[40:43]
    s_waitcnt vmcnt(5)
    v_mfma_f32_16x16x32_bf16 v[32:35], v[76:79], v[200:203], v[32:35]
    s_waitcnt vmcnt(4)
    v_mfma_f32_16x16x32_bf16 v[36:39], v[76:79], v[204:207], v[36:39]
    s_waitcnt vmcnt(3)
    v_mfma_f32_16x16x32_bf16 v[40:43], v[76:79], v[208:211], v[40:43]
    s_waitcnt vmcnt(2)
    v_mfma_f32_16x16x32_bf16 v[32:35], v[80:83], v[212:215], v[32:35]
    s_waitcnt vmcnt(1)
    v_mfma_f32_16x16x32_bf16 v[36:39], v[80:83], v[216:219], v[36:39]
    s_waitcnt vmcnt(0)
    v_mfma_f32_16x16x32_bf16 v[40:43], v[80:83], v[220:223], v[40:43]
    s_mov_b32 exec_lo, 0xff00ff
    s_mov_b32 exec_hi, 0xff00ff00
    s_nop 3
    ds_write_b128 v22, v[32:35] offset:512
    ds_write_b128 v22, v[36:39] offset:768
    ds_write_b128 v22, v[40:43] offset:1024
    s_mov_b64 exec, 1
    ds_add_rtn_u32 v28, v7, v6 offset:16
    s_mov_b32 exec_lo, -1
    s_mov_b32 exec_hi, 0xffffff
    ds_read_b128 v[104:107], v94 offset:512
    ds_read_b128 v[108:111], v94 offset:1296
    ds_read_b128 v[112:115], v94 offset:2080
    ds_read_b128 v[116:119], v94 offset:2864
    ds_read_b128 v[120:123], v94 offset:3648
    ds_read_b128 v[124:127], v94 offset:4432
    ds_read_b128 v[128:131], v94 offset:5216
    ds_read_b128 v[132:135], v94 offset:6000
    s_waitcnt lgkmcnt(8)
    v_readfirstlane_b32 s37, v28
    s_cmp_eq_u32 s37, 3
    s_cbranch_scc0 L_fin
    s_waitcnt lgkmcnt(6)
    v_pk_add_f32 v[104:105], v[104:105], v[108:109]
    v_pk_add_f32 v[106:107], v[106:107], v[110:111]
    s_waitcnt lgkmcnt(4)
    v_pk_add_f32 v[112:113], v[112:113], v[116:117]
    v_pk_add_f32 v[114:115], v[114:115], v[118:119]
    s_waitcnt lgkmcnt(2)
    v_pk_add_f32 v[120:121], v[120:121], v[124:125]
    v_pk_add_f32 v[122:123], v[122:123], v[126:127]
    v_pk_add_f32 v[104:105], v[104:105], v[112:113]
    v_pk_add_f32 v[106:107], v[106:107], v[114:115]
    s_waitcnt lgkmcnt(0)
    v_pk_add_f32 v[128:129], v[128:129], v[132:133]
    v_pk_add_f32 v[130:131], v[130:131], v[134:135]
    v_pk_add_f32 v[104:105], v[104:105], v[120:121]
    v_pk_add_f32 v[106:107], v[106:107], v[122:123]
    v_pk_add_f32 v[104:105], v[104:105], v[128:129]
    v_pk_add_f32 v[106:107], v[106:107], v[130:131]
    v_and_or_b32 v104, v104, v92, v88
    v_and_or_b32 v105, v105, v92, v89
    v_and_or_b32 v106, v106, v92, v90
    v_and_or_b32 v107, v107, v92, v91
    global_store_dwordx4 v93, v[104:107], s[28:29]
    s_barrier
    ds_read_b32 v51, v7 offset:452
    s_waitcnt lgkmcnt(0)
    v_readfirstlane_b32 s71, v51
    s_cmp_eq_u32 s71, 0
    s_cbranch_scc0 L_pubend
    s_mov_b32 exec_lo, -1
    s_mov_b32 exec_hi, 0xffffff
    s_xor_b32 s37, s36, s70
    s_lshr_b32 s37, s37, 24
    v_xor_b32 v107, s37, v107
    global_store_dwordx4 v93, v[104:107], s[64:65] sc1
L_pubend:
    s_endpgm
L_F:
    global_load_dword v17, v3, s[4:5] offset:4
    v_subrev_u32 v20, 3072, v2
    global_load_dwordx4 v[92:95], v20, s[18:19] offset:-3072 nt
    global_load_dwordx4 v[96:99], v20, s[18:19] offset:-2944 nt
    global_load_dwordx4 v[100:103], v20, s[18:19] offset:-2816 nt
    s_load_dword s36, s[28:29], 0
    s_barrier
    v_and_b32 v24, 1, v1
    v_cmp_eq_u32 vcc, 1, v24
    v_mov_b32 v8, 0x0c0c0100
    v_mov_b32 v9, 0x01000c0c
    v_cndmask_b32 v24, v8, v9, vcc
    v_mov_b32 v8, 0x0c0c0302
    v_mov_b32 v9, 0x03020c0c
    v_cndmask_b32 v25, v8, v9, vcc
    v_bfe_u32 v26, v1, 1, 2
    v_mov_b32 v27, 0x0c0c0c0c
    v_cmp_eq_u32 vcc, 0, v26
    s_nop 1
    v_cndmask_b32 v8, v27, v24, vcc
    v_cndmask_b32 v12, v27, v25, vcc
    v_cmp_eq_u32 vcc, 1, v26
    s_nop 1
    v_cndmask_b32 v9, v27, v24, vcc
    v_cndmask_b32 v13, v27, v25, vcc
    v_cmp_eq_u32 vcc, 2, v26
    s_nop 1
    v_cndmask_b32 v10, v27, v24, vcc
    v_cndmask_b32 v14, v27, v25, vcc
    v_cmp_eq_u32 vcc, 3, v26
    s_nop 1
    v_cndmask_b32 v11, v27, v24, vcc
    v_cndmask_b32 v15, v27, v25, vcc
    v_lshrrev_b32 v22, 5, v1
    s_lshl_b32 s37, s30, 1
    v_add_u32 v22, s37, v22
    v_mul_u32_u24 v22, 784, v22
    v_lshl_add_u32 v22, v5, 1, v22
    v_and_b32 v3, 16, v1
    v_add_u32 v22, v22, v3
    s_add_u32 s64, s28, 2097152
    s_addc_u32 s65, s29, 0
    s_getreg_b32 s70, hwreg(HW_REG_XCC_ID, 0, 4)
    s_lshl_b32 s70, s70, 24
    s_mov_b32 s46, 0x0c0c0400
    s_mov_b32 s47, 0x05040100
    s_lshl_b32 s37, s33, 11
    s_add_u32 s37, s37, 589824
    v_lshlrev_b32 v62, 4, v1
    v_add_u32 v61, s37, v62
    s_waitcnt vmcnt(10)
    v_perm_b32 v24, v16, v16, v8
    v_perm_b32 v25, v16, v16, v9
    v_perm_b32 v26, v16, v16, v10
    v_perm_b32 v27, v16, v16, v11
    v_perm_b32 v28, v16, v16, v12
    v_perm_b32 v29, v16, v16, v13
    v_perm_b32 v30, v16, v16, v14
    v_perm_b32 v31, v16, v16, v15
    s_nop 1
    s_waitcnt vmcnt(9)
    v_mfma_f32_16x16x32_bf16 v[32:35], v[24:27], v[64:67], 0
    global_load_dwordx4 v[104:107], v20, s[18:19] offset:0 nt
    s_waitcnt vmcnt(9)
    v_mfma_f32_16x16x32_bf16 v[36:39], v[24:27], v[68:71], 0
    s_waitcnt vmcnt(8)
    v_mfma_f32_16x16x32_bf16 v[40:43], v[24:27], v[72:75], 0
    s_waitcnt vmcnt(7)
    v_mfma_f32_16x16x32_bf16 v[32:35], v[28:31], v[76:79], v[32:35]
    s_waitcnt vmcnt(6)
    v_mfma_f32_16x16x32_bf16 v[36:39], v[28:31], v[80:83], v[36:39]
    s_waitcnt vmcnt(5)
    v_mfma_f32_16x16x32_bf16 v[40:43], v[28:31], v[84:87], v[40:43]
    global_load_dwordx4 v[108:111], v20, s[18:19] offset:128 nt
    s_waitcnt vmcnt(5)
    global_load_dwordx4 v[112:115], v20, s[18:19] offset:256 nt
    s_waitcnt vmcnt(5)
    v_mfma_f32_16x16x32_bf16 v[44:47], v[24:27], v[92:95], 0
    global_load_ushort v18, v19, s[4:5]
    s_waitcnt vmcnt(5)
    v_mfma_f32_16x16x32_bf16 v[48:51], v[24:27], v[96:99], 0
    global_load_dwordx4 v[120:123], v2, s[16:17] offset:0 nt
    s_waitcnt vmcnt(5)
    s_branch L_pads4
L_pad4:
    s_setpc_b64 s[74:75]
L_pads4:
    v_mfma_f32_16x16x32_bf16 v[52:55], v[24:27], v[100:103], 0
    global_load_dwordx4 v[124:127], v2, s[16:17] offset:128 nt
    s_waitcnt vmcnt(5)
    v_mfma_f32_16x16x32_bf16 v[44:47], v[28:31], v[104:107], v[44:47]
    global_load_dwordx4 v[128:131], v2, s[16:17] offset:256 nt
    s_waitcnt vmcnt(5)
    v_mfma_f32_16x16x32_bf16 v[48:51], v[28:31], v[108:111], v[48:51]
    global_load_dwordx4 v[132:135], v2, s[18:19] offset:0 nt
    s_waitcnt vmcnt(5)
    v_mfma_f32_16x16x32_bf16 v[52:55], v[28:31], v[112:115], v[52:55]
    global_load_dwordx4 v[136:139], v2, s[18:19] offset:128 nt
    s_waitcnt vmcnt(5)
    global_load_dwordx4 v[140:143], v2, s[18:19] offset:256 nt
    s_waitcnt vmcnt(5)
    v_perm_b32 v24, v17, v17, v8
    v_perm_b32 v25, v17, v17, v9
    v_perm_b32 v26, v17, v17, v10
    v_perm_b32 v27, v17, v17, v11
    s_nop 1
    v_mfma_f32_16x16x32_bf16 v[32:35], v[24:27], v[120:123], v[32:35]
    global_load_dwordx4 v[144:147], v2, s[16:17] offset:3072 nt
    s_mov_b64 exec, 1
    ds_add_u32 v7, v6 offset:8
    s_mov_b64 exec, -1
    s_waitcnt vmcnt(5)
    v_mfma_f32_16x16x32_bf16 v[36:39], v[24:27], v[124:127], v[36:39]
    global_load_dwordx4 v[148:151], v2, s[16:17] offset:3200 nt
    s_waitcnt vmcnt(5)
    v_mfma_f32_16x16x32_bf16 v[40:43], v[24:27], v[128:131], v[40:43]
    global_load_dwordx4 v[152:155], v2, s[16:17] offset:3328 nt
    s_waitcnt vmcnt(5)
    v_mfma_f32_16x16x32_bf16 v[44:47], v[24:27], v[132:135], v[44:47]
    global_load_dwordx4 v[156:159], v2, s[18:19] offset:3072 nt
    s_waitcnt vmcnt(5)
    v_mfma_f32_16x16x32_bf16 v[48:51], v[24:27], v[136:139], v[48:51]
    global_load_dwordx4 v[160:163], v2, s[18:19] offset:3200 nt
    s_waitcnt vmcnt(5)
    v_mfma_f32_16x16x32_bf16 v[52:55], v[24:27], v[140:143], v[52:55]
    global_load_dwordx4 v[164:167], v2, s[18:19] offset:3328 nt
    s_waitcnt vmcnt(5)
    v_perm_b32 v28, v17, v17, v12
    v_perm_b32 v29, v17, v17, v13
    v_perm_b32 v30, v17, v17, v14
    v_perm_b32 v31, v17, v17, v15
    s_mov_b32 s39, 0
L_sp29:
    ds_read_b32 v63, v7 offset:4
    s_add_u32 s39, s39, 1
    s_waitcnt lgkmcnt(0)
    v_readfirstlane_b32 s61, v63
    s_cmp_ge_u32 s61, 4
    s_cbranch_scc1 L_spd30
    s_sleep 1
    s_cmp_lt_u32 s39, 0x9c400
    s_cbranch_scc1 L_sp29
L_spd30:
    s_waitcnt lgkmcnt(0)
    s_add_u32 s36, s36, 0x01010101
    s_xor_b32 s70, s70, s36
    v_mov_b32 v59, s70
    v_and_b32 v56, 0xff, v59
    v_bfe_u32 v57, v59, 8, 8
    v_bfe_u32 v58, v59, 16, 8
    v_lshrrev_b32 v59, 24, v59
    v_mov_b32 v60, 0xffffff00
    v_mfma_f32_16x16x32_bf16 v[32:35], v[28:31], v[144:147], v[32:35]
    global_load_dwordx4 v[168:171], v23, s[16:17] offset:0 nt
    s_waitcnt vmcnt(5)
    v_mfma_f32_16x16x32_bf16 v[36:39], v[28:31], v[148:151], v[36:39]
    global_load_dwordx4 v[172:175], v23, s[16:17] offset:128 nt
    s_mov_b64 exec, 1
    ds_add_u32 v7, v6 offset:28
    s_mov_b64 exec, -1
    s_waitcnt vmcnt(5)
    v_mfma_f32_16x16x32_bf16 v[40:43], v[28:31], v[152:155], v[40:43]
    global_load_dwordx4 v[176:179], v23, s[16:17] offset:256 nt
    s_waitcnt vmcnt(5)
    v_mfma_f32_16x16x32_bf16 v[44:47], v[28:31], v[156:159], v[44:47]
    global_load_dwordx4 v[180:183], v23, s[18:19] offset:0 nt
    s_waitcnt vmcnt(5)
    v_mfma_f32_16x16x32_bf16 v[48:51], v[28:31], v[160:163], v[48:51]
    global_load_dwordx4 v[184:187], v23, s[18:19] offset:128 nt
    s_waitcnt vmcnt(5)
    v_mfma_f32_16x16x32_bf16 v[52:55], v[28:31], v[164:167], v[52:55]
    global_load_dwordx4 v[188:191], v23, s[18:19] offset:256 nt
    s_mov_b64 exec, 1
    ds_add_u32 v7, v6 offset:12
    s_mov_b64 exec, -1
    s_waitcnt vmcnt(5)
    v_perm_b32 v24, v18, v18, v8
    v_perm_b32 v25, v18, v18, v9
    v_perm_b32 v26, v18, v18, v10
    v_perm_b32 v27, v18, v18, v11
    s_nop 1
    v_mfma_f32_16x16x32_bf16 v[32:35], v[24:27], v[168:171], v[32:35]
    s_waitcnt vmcnt(4)
    v_mfma_f32_16x16x32_bf16 v[36:39], v[24:27], v[172:175], v[36:39]
    s_waitcnt vmcnt(3)
    v_mfma_f32_16x16x32_bf16 v[40:43], v[24:27], v[176:179], v[40:43]
    s_waitcnt vmcnt(2)
    v_mfma_f32_16x16x32_bf16 v[44:47], v[24:27], v[180:183], v[44:47]
    s_waitcnt vmcnt(1)
    v_mfma_f32_16x16x32_bf16 v[48:51], v[24:27], v[184:187], v[48:51]
    s_waitcnt vmcnt(0)
    v_mfma_f32_16x16x32_bf16 v[52:55], v[24:27], v[188:191], v[52:55]
    s_mov_b32 exec_lo, 0xff00ff
    s_mov_b32 exec_hi, 0xff00ff00
    s_nop 0
    ds_write_b128 v22, v[32:35] offset:512
    ds_write_b128 v22, v[36:39] offset:768
    ds_write_b128 v22, v[40:43] offset:1024
    ds_write_b128 v22, v[44:47] offset:6784
    ds_write_b128 v22, v[48:51] offset:7040
    ds_write_b128 v22, v[52:55] offset:7296
    s_mov_b64 exec, 1
    ds_add_rtn_u32 v24, v7, v6 offset:16
    s_mov_b64 exec, -1
    s_waitcnt lgkmcnt(0)
    v_readfirstlane_b32 s37, v24
    s_cmp_eq_u32 s37, 3
    s_cbranch_scc0 L_fin
    ds_read_b32 v25, v7 offset:452
    ds_read_b128 v[64:67], v62 offset:512
    ds_read_b128 v[68:71], v62 offset:1296
    ds_read_b128 v[72:75], v62 offset:2080
    ds_read_b128 v[76:79], v62 offset:2864
    ds_read_b128 v[80:83], v62 offset:3648
    ds_read_b128 v[84:87], v62 offset:4432
    ds_read_b128 v[88:91], v62 offset:5216
    ds_read_b128 v[92:95], v62 offset:6000
    s_waitcnt lgkmcnt(6)
    v_pk_add_f32 v[64:65], v[64:65], v[68:69]
    v_pk_add_f32 v[66:67], v[66:67], v[70:71]
    s_waitcnt lgkmcnt(4)
    v_pk_add_f32 v[72:73], v[72:73], v[76:77]
    v_pk_add_f32 v[74:75], v[74:75], v[78:79]
    s_waitcnt lgkmcnt(2)
    v_pk_add_f32 v[80:81], v[80:81], v[84:85]
    v_pk_add_f32 v[82:83], v[82:83], v[86:87]
    v_pk_add_f32 v[64:65], v[64:65], v[72:73]
    v_pk_add_f32 v[66:67], v[66:67], v[74:75]
    s_waitcnt lgkmcnt(0)
    v_pk_add_f32 v[88:89], v[88:89], v[92:93]
    v_pk_add_f32 v[90:91], v[90:91], v[94:95]
    v_pk_add_f32 v[64:65], v[64:65], v[80:81]
    v_pk_add_f32 v[66:67], v[66:67], v[82:83]
    v_pk_add_f32 v[64:65], v[64:65], v[88:89]
    v_pk_add_f32 v[66:67], v[66:67], v[90:91]
    ds_read_b128 v[96:99], v62 offset:6784
    ds_read_b128 v[100:103], v62 offset:7568
    ds_read_b128 v[104:107], v62 offset:8352
    ds_read_b128 v[108:111], v62 offset:9136
    ds_read_b128 v[112:115], v62 offset:9920
    ds_read_b128 v[116:119], v62 offset:10704
    ds_read_b128 v[120:123], v62 offset:11488
    ds_read_b128 v[124:127], v62 offset:12272
    s_branch L_pads5
L_pad5:
    s_setpc_b64 s[74:75]
L_pads5:
    v_and_or_b32 v64, v64, v60, v56
    v_and_or_b32 v65, v65, v60, v57
    v_and_or_b32 v66, v66, v60, v58
    v_and_or_b32 v67, v67, v60, v59
    s_mov_b32 exec_hi, 0xffff
    global_store_dwordx4 v61, v[64:67], s[28:29]
    s_waitcnt lgkmcnt(6)
    v_pk_add_f32 v[96:97], v[96:97], v[100:101]
    v_pk_add_f32 v[98:99], v[98:99], v[102:103]
    s_waitcnt lgkmcnt(4)
    v_pk_add_f32 v[104:105], v[104:105], v[108:109]
    v_pk_add_f32 v[106:107], v[106:107], v[110:111]
    s_waitcnt lgkmcnt(2)
    v_pk_add_f32 v[112:113], v[112:113], v[116:117]
    v_pk_add_f32 v[114:115], v[114:115], v[118:119]
    v_pk_add_f32 v[96:97], v[96:97], v[104:105]
    v_pk_add_f32 v[98:99], v[98:99], v[106:107]
    s_waitcnt lgkmcnt(0)
    v_pk_add_f32 v[120:121], v[120:121], v[124:125]
    v_pk_add_f32 v[122:123], v[122:123], v[126:127]
    v_pk_add_f32 v[96:97], v[96:97], v[112:113]
    v_pk_add_f32 v[98:99], v[98:99], v[114:115]
    v_pk_add_f32 v[96:97], v[96:97], v[120:121]
    v_pk_add_f32 v[98:99], v[98:99], v[122:123]
    v_and_or_b32 v96, v96, v60, v56
    v_and_or_b32 v97, v97, v60, v57
    v_and_or_b32 v98, v98, v60, v58
    v_and_or_b32 v99, v99, v60, v59
    global_store_dwordx4 v61, v[96:99], s[28:29] offset:1024
    s_barrier
    v_readfirstlane_b32 s71, v25
    s_cmp_eq_u32 s71, 0
    s_cbranch_scc0 L_pubend
    s_mov_b32 exec_lo, -1
    s_mov_b32 exec_hi, 0xffff
    s_xor_b32 s37, s36, s70
    s_lshr_b32 s37, s37, 24
    v_xor_b32 v67, s37, v67
    v_xor_b32 v99, s37, v99
    global_store_dwordx4 v61, v[64:67], s[64:65] sc1
    global_store_dwordx4 v61, v[96:99], s[64:65] offset:1024 sc1
    s_branch L_pubend
L_helper:
    s_sub_u32 s30, s30, 4
    s_add_u32 s64, s28, 2097152
    s_addc_u32 s65, s29, 0
    s_getreg_b32 s70, hwreg(HW_REG_XCC_ID, 0, 4)
    s_lshl_b32 s70, s70, 24
    s_mov_b32 s46, 0x0c0c0400
    s_mov_b32 s47, 0x05040100
    s_waitcnt lgkmcnt(0)
    s_add_u32 s36, s36, 0x01010101
    s_xor_b32 s70, s70, s36
    s_mov_b64 exec, 1
    ds_add_u32 v7, v6 offset:448
    s_mov_b64 exec, -1
    s_cmp_eq_u32 s30, 2
    s_cbranch_scc0 L_ng
    s_cmp_eq_u32 s2, 224
    s_cbranch_scc0 L_ng
    v_lshrrev_b32 v2, 2, v1
    v_and_b32 v3, 3, v1
    v_lshlrev_b32 v3, 4, v3
    v_lshl_add_u32 v2, v2, 7, v3
    v_add_u32 v2, 655360+2048, v2
    v_mov_b32 v8, 0
    v_mov_b32 v9, 0
    v_mov_b32 v10, 0
    v_mov_b32 v11, 0
    global_store_dwordx4 v2, v[8:11], s[28:29] offset:-2048 sc1
    global_store_dwordx4 v2, v[8:11], s[28:29] sc1
    global_store_dwordx4 v2, v[8:11], s[28:29] offset:2048 sc1
    v_mul_u32_u24 v3, 20, v1
    global_load_dwordx4 v[16:19], v3, s[4:5]
    global_load_dword v20, v3, s[4:5] offset:16
    global_load_dwordx4 v[24:27], v3, s[22:23]
    global_load_dword v28, v3, s[22:23] offset:16
    v_mov_b32 v30, 0
    s_waitcnt vmcnt(0)
    v_lshlrev_b32 v32, 16, v16
    v_and_b32 v33, 0xffff0000, v16
    v_lshlrev_b32 v34, 16, v24
    v_and_b32 v35, 0xffff0000, v24
    v_mul_f32 v32, v32, v34
    v_mul_f32 v33, v33, v35
    v_cvt_pk_bf16_f32 v32, v32, v33
    v_lshlrev_b32 v33, 16, v32
    v_and_b32 v32, 0xffff0000, v32
    v_add_f32 v30, v30, v33
    v_add_f32 v30, v30, v32
    v_lshlrev_b32 v32, 16, v17
    v_and_b32 v33, 0xffff0000, v17
    v_lshlrev_b32 v34, 16, v25
    v_and_b32 v35, 0xffff0000, v25
    v_mul_f32 v32, v32, v34
    v_mul_f32 v33, v33, v35
    v_cvt_pk_bf16_f32 v32, v32, v33
    v_lshlrev_b32 v33, 16, v32
    v_and_b32 v32, 0xffff0000, v32
    v_add_f32 v30, v30, v33
    v_add_f32 v30, v30, v32
    v_lshlrev_b32 v32, 16, v18
    v_and_b32 v33, 0xffff0000, v18
    v_lshlrev_b32 v34, 16, v26
    v_and_b32 v35, 0xffff0000, v26
    v_mul_f32 v32, v32, v34
    v_mul_f32 v33, v33, v35
    v_cvt_pk_bf16_f32 v32, v32, v33
    v_lshlrev_b32 v33, 16, v32
    v_and_b32 v32, 0xffff0000, v32
    v_add_f32 v30, v30, v33
    v_add_f32 v30, v30, v32
    v_lshlrev_b32 v32, 16, v19
    v_and_b32 v33, 0xffff0000, v19
    v_lshlrev_b32 v34, 16, v27
    v_and_b32 v35, 0xffff0000, v27
    v_mul_f32 v32, v32, v34
    v_mul_f32 v33, v33, v35
    v_cvt_pk_bf16_f32 v32, v32, v33
    v_lshlrev_b32 v33, 16, v32
    v_and_b32 v32, 0xffff0000, v32
    v_add_f32 v30, v30, v33
    v_add_f32 v30, v30, v32
    v_lshlrev_b32 v32, 16, v20
    v_and_b32 v33, 0xffff0000, v20
    v_lshlrev_b32 v34, 16, v28
    v_and_b32 v35, 0xffff0000, v28
    v_mul_f32 v32, v32, v34
    v_mul_f32 v33, v33, v35
    v_cvt_pk_bf16_f32 v32, v32, v33
    v_lshlrev_b32 v33, 16, v32
    v_and_b32 v32, 0xffff0000, v32
    v_add_f32 v30, v30, v33
    v_add_f32 v30, v30, v32
    s_nop 1
    v_add_f32_dpp v30, v30, v30 quad_perm:[1,0,3,2] row_mask:0xf bank_mask:0xf
    s_nop 1
    v_add_f32_dpp v30, v30, v30 quad_perm:[2,3,0,1] row_mask:0xf bank_mask:0xf
    s_nop 1
    v_add_f32_dpp v30, v30, v30 row_half_mirror row_mask:0xf bank_mask:0xf
    s_nop 1
    v_add_f32_dpp v30, v30, v30 row_mirror row_mask:0xf bank_mask:0xf
    v_mov_b32 v31, v30
    s_nop 1
    v_permlane16_swap_b32 v30, v31
    s_nop 1
    v_add_f32 v30, v30, v31
    v_mov_b32 v31, v30
    s_nop 1
    v_permlane32_swap_b32 v30, v31
    s_nop 1
    v_add_f32 v30, v30, v31
    v_cvt_pk_bf16_f32 v30, v30, v30
    v_lshlrev_b32 v30, 16, v30
    v_mul_f32 v30, 0xbfb8aa3b, v30
    v_exp_f32 v30, v30
    s_nop 0
    v_add_f32 v30, 1.0, v30
    v_rcp_f32 v30, v30
    s_nop 0
    v_cvt_pk_bf16_f32 v30, v30, v30
    v_lshlrev_b32 v30, 16, v30
    v_sub_f32 v31, 1.0, v30
    v_cvt_pk_bf16_f32 v31, v31, v31
    v_lshlrev_b32 v31, 16, v31
    v_mov_b32 v28, s36
    v_mov_b32 v29, s36
    v_mov_b32 v3, 32768
    s_mov_b64 exec, 1
    global_store_dwordx4 v3, v[28:31], s[28:29] sc1
    s_mov_b64 exec, -1
L_ng:
    s_cmp_eq_u32 s34, 7
    s_cbranch_scc1 L_fh
    v_lshrrev_b32 v2, 4, v1
    v_and_b32 v3, 15, v1
    s_mul_i32 s45, s30, 192
    v_lshlrev_b32 v4, 4, v3
    v_add_u32 v4, s45, v4
    s_mov_b32 s50, 0x0fff0fff
    s_branch L_pads6
L_pad6:
    s_setpc_b64 s[74:75]
L_pads6:
    s_mov_b32 s51, 0x0fff0fff
    s_mov_b32 s54, 0x0fff
    s_lshl_b32 s37, s33, 13
    s_add_u32 s37, s37, 65536
    v_lshl_add_u32 v17, v2, 10, v4
    v_add_u32 v17, s37, v17
    s_lshl_b32 s38, s34, 10
    s_add_u32 s37, s37, s38
    v_lshlrev_b32 v18, 4, v1
    v_add_u32 v19, s37, v18
    v_lshrrev_b32 v20, 1, v4
    v_lshl_add_u32 v20, v2, 1, v20
    v_add_u32 v21, 4096, v17
    v_mov_b32 v15, s70
    v_and_b32 v12, 0xff, v15
    v_bfe_u32 v13, v15, 8, 8
    v_bfe_u32 v14, v15, 16, 8
    v_lshrrev_b32 v15, 24, v15
    v_mov_b32 v16, 0xffffff00
    v_mov_b32 v28, 0
    v_mov_b32 v29, 0
    v_mov_b32 v30, 0
    v_mov_b32 v31, 0
    v_mov_b32 v39, 0
    v_mov_b32 v56, 0
    v_mov_b32 v57, 0
    v_mov_b32 v58, 0
    v_mov_b32 v59, 0
    s_mov_b64 exec, s[50:51]
    v_mov_b32 v39, 0xff
    s_mov_b32 exec_hi, s54
    v_mov_b32 v56, v12
    v_mov_b32 v57, v13
    v_mov_b32 v58, v14
    v_mov_b32 v59, v15
    s_mov_b64 exec, -1
    s_mov_b32 s39, 0
L_sp32:
    ds_read_b32 v22, v7 offset:0
    s_add_u32 s39, s39, 1
    s_waitcnt lgkmcnt(0)
    v_readfirstlane_b32 s61, v22
    s_cmp_ge_u32 s61, 4
    s_cbranch_scc1 L_spd33
    s_sleep 1
    s_cmp_lt_u32 s39, 0x9c400
    s_cbranch_scc1 L_sp32
L_spd33:
    s_cmp_eq_u32 s30, 0
    s_cbranch_scc0 L_qg
    ds_read_b128 v[64:67], v18 offset:512
    ds_read_b128 v[68:71], v18 offset:1296
    ds_read_b128 v[72:75], v18 offset:2080
    ds_read_b128 v[76:79], v18 offset:2864
    ds_read_b128 v[80:83], v18 offset:3648
    ds_read_b128 v[84:87], v18 offset:4432
    ds_read_b128 v[88:91], v18 offset:5216
    ds_read_b128 v[92:95], v18 offset:6000
    s_waitcnt lgkmcnt(6)
    v_pk_add_f32 v[64:65], v[64:65], v[68:69]
    v_pk_add_f32 v[66:67], v[66:67], v[70:71]
    s_waitcnt lgkmcnt(4)
    v_pk_add_f32 v[72:73], v[72:73], v[76:77]
    v_pk_add_f32 v[74:75], v[74:75], v[78:79]
    s_waitcnt lgkmcnt(2)
    v_pk_add_f32 v[80:81], v[80:81], v[84:85]
    v_pk_add_f32 v[82:83], v[82:83], v[86:87]
    v_pk_add_f32 v[64:65], v[64:65], v[72:73]
    v_pk_add_f32 v[66:67], v[66:67], v[74:75]
    s_waitcnt lgkmcnt(0)
    v_pk_add_f32 v[88:89], v[88:89], v[92:93]
    v_pk_add_f32 v[90:91], v[90:91], v[94:95]
    v_pk_add_f32 v[64:65], v[64:65], v[80:81]
    v_pk_add_f32 v[66:67], v[66:67], v[82:83]
    v_pk_add_f32 v[64:65], v[64:65], v[88:89]
    v_pk_add_f32 v[66:67], v[66:67], v[90:91]
    v_and_or_b32 v64, v64, v16, v12
    v_and_or_b32 v65, v65, v16, v13
    v_and_or_b32 v66, v66, v16, v14
    v_and_or_b32 v67, v67, v16, v15
    s_mov_b32 exec_hi, 0xffff
    global_store_dwordx4 v19, v[64:67], s[28:29]
L_qg:
    s_mov_b64 exec, -1
    s_mov_b32 s39, 0
L_sp35:
    ds_read_b32 v22, v7 offset:24
    s_add_u32 s39, s39, 1
    s_waitcnt lgkmcnt(0)
    v_readfirstlane_b32 s61, v22
    s_cmp_ge_u32 s61, 4
    s_cbranch_scc1 L_spd36
    s_sleep 1
    s_cmp_lt_u32 s39, 0x9c400
    s_cbranch_scc1 L_sp35
L_spd36:
    s_mov_b32 s39, -1
L_qpl:
    s_add_u32 s39, s39, 1
    s_cmp_ge_u32 s39, 8
    s_cbranch_scc1 L_qslow
    s_mov_b64 exec, s[50:51]
    global_load_dwordx4 v[24:27], v17, s[28:29] sc1
    s_mov_b32 exec_hi, s54
    global_load_dwordx4 v[28:31], v21, s[28:29] sc1
    s_mov_b64 exec, -1
    s_waitcnt vmcnt(1)
    v_xor_b32 v24, v12, v24
    v_xor_b32 v25, v13, v25
    v_xor_b32 v26, v14, v26
    v_xor_b32 v27, v15, v27
    v_or3_b32 v32, v24, v25, v26
    s_waitcnt vmcnt(0)
    v_xor_b32 v28, v56, v28
    v_xor_b32 v29, v57, v29
    v_xor_b32 v30, v58, v30
    v_xor_b32 v31, v59, v31
    v_or3_b32 v32, v32, v27, v28
    v_or3_b32 v32, v32, v29, v30
    v_bitop3_b32 v32, v32, v31, v39 bitop3:0xa8
    v_cmp_ne_u32 vcc, 0, v32
    s_or_b64 vcc, vcc, vcc
    s_cbranch_scc1 L_qpl
L_qgot:
    v_pk_add_f32 v[24:25], v[24:25], v[28:29]
    v_pk_add_f32 v[26:27], v[26:27], v[30:31]
    s_nop 1
    v_permlane32_swap_b32 v24, v26
    v_permlane32_swap_b32 v25, v27
    s_nop 1
    v_add_f32 v24, v24, v26
    v_add_f32 v25, v25, v27
    s_nop 1
    v_permlane16_swap_b32 v24, v25
    s_nop 1
    v_add_f32 v24, v24, v25
    v_cvt_pk_bf16_f32 v24, v24, v24
    s_mov_b64 exec, s[50:51]
    ds_write_b16 v20, v24 offset:64
    s_mov_b64 exec, 1
    ds_add_u32 v7, v6 offset:4
    s_mov_b64 exec, -1
    s_cmp_eq_u32 s30, 3
    s_cbranch_scc0 L_tk
L_hc:
    v_mov_b32 v44, 32768
    s_mov_b64 exec, 1
    global_load_dwordx4 v[48:51], v44, s[28:29] sc1
    s_mov_b64 exec, -1
    s_lshl_b32 s37, s31, 15
    s_add_u32 s37, s37, 65536
    v_lshlrev_b32 v36, 10, v1
    v_add_u32 v36, s37, v36
    s_mov_b32 s39, 0
    s_mov_b32 exec_hi, 0
L_ahl:
    s_sleep 1
    global_load_dwordx4 v[40:43], v36, s[28:29] sc1
    s_add_u32 s39, s39, 1
    s_waitcnt vmcnt(0)
    v_perm_b32 v32, v41, v40, s46
    v_perm_b32 v33, v43, v42, s46
    v_perm_b32 v32, v33, v32, s47
    v_cmp_ne_u32 vcc, s70, v32
    s_or_b64 vcc, vcc, vcc
    s_cbranch_scc0 L_ahy
    s_cmp_lt_u32 s39, 4
    s_cbranch_scc1 L_ahl
    s_branch L_ahn
L_ahy:
    ds_write_b32 v7, v6 offset:452
L_ahn:
    s_mov_b32 exec_hi, -1
    s_mov_b32 s39, 0
    s_mov_b64 exec, 1
L_ic:
    v_readfirstlane_b32 s37, v48
    ds_write_b64 v7, v[50:51] offset:464
    s_cmp_eq_u32 s37, s36
    s_cbranch_scc1 L_tk
    global_load_dwordx4 v[48:51], v44, s[28:29] sc1
    s_add_u32 s39, s39, 1
    s_cmp_lt_u32 s39, 40000
    s_waitcnt vmcnt(0)
    s_cbranch_scc1 L_ic
L_tk:
    s_mov_b64 exec, -1
    v_lshrrev_b32 v2, 4, v1
    v_and_b32 v3, 15, v1
    v_mul_u32_u24 v17, 1280, v2
    v_lshl_add_u32 v17, v3, 4, v17
    s_mul_i32 s44, s30, 768
    v_lshlrev_b32 v18, 5, v3
    v_lshl_add_u32 v18, v2, 4, v18
    v_add_u32 v18, s44, v18
    v_mov_b32 v19, s44
    ds_write_b32 v19, v7 offset:14080
    s_branch L_pads7
L_pad7:
    s_setpc_b64 s[74:75]
L_pads7:
    v_and_b32 v19, 1, v1
    v_cmp_eq_u32 vcc, 1, v19
    v_mov_b32 v19, 0xffff
    v_mov_b32 v20, 0xffff0000
    v_cndmask_b32 v19, v19, v20, vcc
    v_bfe_u32 v20, v1, 1, 2
    s_mul_i32 s45, s30, 192
    v_lshlrev_b32 v4, 4, v3
    v_add_u32 v4, s45, v4
    v_cmp_eq_u32 vcc, 0, v20
    s_nop 1
    v_cndmask_b32 v8, v7, v19, vcc
    v_cmp_eq_u32 vcc, 1, v20
    s_nop 1
    v_cndmask_b32 v9, v7, v19, vcc
    v_cmp_eq_u32 vcc, 2, v20
    s_nop 1
    v_cndmask_b32 v10, v7, v19, vcc
    v_cmp_eq_u32 vcc, 3, v20
    s_nop 1
    v_cndmask_b32 v11, v7, v19, vcc
    v_mov_b32 v15, s70
    v_and_b32 v12, 0xff, v15
    v_bfe_u32 v13, v15, 8, 8
    v_bfe_u32 v14, v15, 16, 8
    v_lshrrev_b32 v15, 24, v15
    v_mov_b32 v16, 0xffffff00
    v_cmp_eq_u32 vcc, 12, v3
    v_mov_b32 v5, 768
    v_mov_b32 v28, 0xff800000
    v_cndmask_b32 v5, v4, v5, vcc
    v_cndmask_b32 v28, v7, v28, vcc
    v_mov_b32 v29, 0
    v_mov_b32 v30, 0
    v_mov_b32 v31, 0
    s_mov_b32 s48, 0x3fb8aa3b
    s_mov_b32 s49, 0x3d372713
    s_mov_b32 s43, 0xc0135761
    v_mul_u32_u24 v124, 15, v2
    v_add_u32 v124, v124, v3
    v_lshlrev_b32 v118, 7, v2
    v_lshl_add_u32 v118, v3, 2, v118
    v_cmp_eq_u32 vcc, 15, v3
    v_mov_b32 v125, 1.0
    s_mov_b32 s56, 0x7fff7fff
    s_mov_b32 s57, 0x7fff7fff
    v_cndmask_b32 v121, v7, v125, vcc
    v_mov_b32 v126, 0x421c0000
    s_mov_b64 s[58:59], 0xff
    v_mov_b32 v120, 512
    v_add_u32 v125, 0, v124
    v_min_u32 v125, 127, v125
    v_lshlrev_b32 v112, 2, v125
    v_cndmask_b32 v112, v120, v112, s[56:57]
    v_lshlrev_b32 v115, 1, v125
    v_add_u32 v125, 60, v124
    v_min_u32 v125, 127, v125
    v_lshlrev_b32 v113, 2, v125
    v_cndmask_b32 v113, v120, v113, s[56:57]
    v_lshlrev_b32 v116, 1, v125
    v_add_u32 v125, 120, v124
    v_min_u32 v125, 127, v125
    v_lshlrev_b32 v114, 2, v125
    v_cndmask_b32 v114, v120, v114, s[58:59]
    v_lshlrev_b32 v117, 1, v125
    v_pk_mov_b32 v[164:165], v[28:29], v[28:29] op_sel:[0,1]
    v_pk_mov_b32 v[166:167], v[30:31], v[30:31] op_sel:[0,1]
    s_mul_i32 s62, s30, 61440
    s_add_u32 s62, s62, 2560
    s_lshl_b32 s67, s31, 2
    s_cmp_eq_u32 s30, 0
    s_cbranch_scc0 L_tk2
    s_lshl_b32 s37, s31, 5
    s_add_u32 s40, s26, s37
    s_addc_u32 s41, s27, 0
    s_mov_b32 s66, 1
    s_mov_b32 s39, 0
L_sp38:
    ds_read_b32 v22, v7 offset:448
    s_add_u32 s39, s39, 1
    s_waitcnt lgkmcnt(0)
    v_readfirstlane_b32 s61, v22
    s_cmp_ge_u32 s61, 4
    s_cbranch_scc1 L_spd39
    s_sleep 1
    s_cmp_lt_u32 s39, 0x9c400
    s_cbranch_scc1 L_sp38
L_spd39:
    s_mov_b32 s39, 0
L_sp41:
    ds_read_b32 v22, v7 offset:28
    s_add_u32 s39, s39, 1
    s_waitcnt lgkmcnt(0)
    v_readfirstlane_b32 s61, v22
    s_cmp_ge_u32 s61, 4
    s_cbranch_scc1 L_spd42
    s_sleep 1
    s_cmp_lt_u32 s39, 0x9c400
    s_cbranch_scc1 L_sp41
L_spd42:
    s_atomic_add s66, s[40:41], 0 glc
    s_waitcnt lgkmcnt(0)
    s_and_b32 s66, s66, 31
    s_add_u32 s66, s66, 1
    v_mov_b32 v22, s66
    ds_write_b32 v7, v22 offset:456
    s_cmp_eq_u32 s66, 32
    s_cbranch_scc0 L_tk2
    s_mov_b32 s37, 1
    s_atomic_add s37, s[26:27], 4 glc
    s_waitcnt lgkmcnt(0)
    s_and_b32 s37, s37, 7
    s_cmp_eq_u32 s37, 7
    s_cbranch_scc0 L_tk2
    v_mov_b32 v23, s36
    s_mov_b64 exec, 1
    global_store_dword v7, v23, s[28:29] sc1
    s_mov_b64 exec, -1
L_tk2:
    s_mov_b32 s39, 0
L_sp44:
    ds_read_b32 v22, v7 offset:456
    s_add_u32 s39, s39, 1
    s_waitcnt lgkmcnt(0)
    v_readfirstlane_b32 s61, v22
    s_cmp_ge_u32 s61, 1
    s_cbranch_scc1 L_spd45
    s_sleep 1
    s_cmp_lt_u32 s39, 0x9c400
    s_cbranch_scc1 L_sp44
L_spd45:
    s_sub_u32 s66, s61, 1
    s_cmp_ge_u32 s66, 25
    s_cbranch_scc1 L_fin
    s_sub_u32 s68, 24, s66
    s_sub_u32 s45, s68, 5
    s_and_b32 s45, s45, 31
    s_mul_i32 s44, s45, 52
    s_lshr_b32 s44, s44, 8
    s_mul_i32 s72, s44, 5
    s_sub_u32 s72, s45, s72
    s_add_u32 s67, s67, s44
    s_cmp_ge_u32 s68, 5
    s_cselect_b32 s42, 1, 0
    s_cselect_b64 s[40:41], s[12:13], s[20:21]
    s_cselect_b32 s67, s67, s31
    s_cselect_b32 s72, s72, s68
    s_mul_i32 s45, s67, 245760
    s_lshl_b32 s38, s72, 8
    s_add_u32 s45, s45, s38
    s_add_u32 s45, s45, s62
    v_add_u32 v17, s45, v17
    s_mov_b32 s39, 0
L_sp47:
    ds_read_b32 v22, v7 offset:12
    s_add_u32 s39, s39, 1
    s_waitcnt lgkmcnt(0)
    v_readfirstlane_b32 s61, v22
    s_cmp_ge_u32 s61, 4
    s_cbranch_scc1 L_spd48
    s_sleep 1
    s_cmp_lt_u32 s39, 0x9c400
    s_cbranch_scc1 L_sp47
L_spd48:
    global_load_dwordx4 v[64:67], v17, s[40:41] offset:-2560 nt
    global_load_dwordx4 v[68:71], v17, s[40:41] offset:2560 nt
    v_add_u32 v17, 10240, v17
    global_load_dwordx4 v[72:75], v17, s[40:41] offset:-2560 nt
    global_load_dwordx4 v[76:79], v17, s[40:41] offset:2560 nt
    v_add_u32 v17, 10240, v17
    global_load_dwordx4 v[80:83], v17, s[40:41] offset:-2560 nt
    global_load_dwordx4 v[84:87], v17, s[40:41] offset:2560 nt
    v_add_u32 v115, s38, v115
    v_add_u32 v116, s38, v116
    v_add_u32 v117, s38, v117
    s_mul_i32 s37, s72, 1152
    s_add_u32 s37, s37, 655360
    v_add_u32 v118, s37, v118
    s_lshl_b32 s37, s67, 13
    s_cmp_eq_u32 s42, 1
    s_cbranch_scc0 L_lh
    s_add_u32 s37, s37, 327680
    v_lshl_add_u32 v20, v2, 10, v5
    v_add_u32 v20, s37, v20
    v_add_u32 v21, 4096, v20
    s_mov_b32 s50, 0x1fff1fff
    s_mov_b32 s51, 0x1fff1fff
    s_mov_b32 s54, 0x1fff
    s_branch L_lc
L_lh:
    s_add_u32 s37, s37, 589824
    v_lshl_add_u32 v20, v2, 11, v4
    v_add_u32 v20, s37, v20
    v_add_u32 v21, 1024, v20
    s_mov_b32 s50, 0x0fff0fff
    s_mov_b32 s51, 0x0fff0fff
    s_mov_b32 s54, 0x0fff0fff
L_lc:
    v_mov_b32 v39, 0
    v_mov_b32 v56, 0
    s_branch L_pads8
L_pad8:
    s_setpc_b64 s[74:75]
L_pads8:
    v_mov_b32 v57, 0
    v_mov_b32 v58, 0
    v_mov_b32 v59, 0
    s_mov_b64 exec, s[50:51]
    v_mov_b32 v39, 0xff
    s_mov_b32 exec_hi, s54
    v_mov_b32 v56, v12
    v_mov_b32 v57, v13
    v_mov_b32 v58, v14
    v_mov_b32 v59, v15
    s_mov_b64 exec, -1
    s_barrier
L_nopw:
    s_mov_b64 exec, s[50:51]
    global_load_dwordx4 v[160:163], v20, s[28:29] sc1
    s_mov_b32 exec_hi, s54
    global_load_dwordx4 v[164:167], v21, s[28:29] sc1
    s_mov_b64 exec, -1
    v_add_u32 v17, 10240, v17
    global_load_dwordx4 v[88:91], v17, s[40:41] offset:-2560 nt
    global_load_dwordx4 v[92:95], v17, s[40:41] offset:2560 nt
    v_add_u32 v17, 10240, v17
    global_load_dwordx4 v[96:99], v17, s[40:41] offset:-2560 nt
    global_load_dwordx4 v[100:103], v17, s[40:41] offset:2560 nt
    v_add_u32 v17, 10240, v17
    global_load_dwordx4 v[104:107], v17, s[40:41] offset:-2560 nt
    global_load_dwordx4 v[108:111], v17, s[40:41] offset:2560 nt
    s_cmp_eq_u32 s42, 1
    s_cselect_b32 s37, 0, 4
    v_mov_b32 v123, s37
    s_mov_b64 s[58:59], 0xff
    s_waitcnt vmcnt(7)
    v_xor_b32 v24, v12, v160
    v_xor_b32 v25, v13, v161
    v_xor_b32 v26, v14, v162
    v_xor_b32 v27, v15, v163
    v_or3_b32 v32, v24, v25, v26
    s_waitcnt vmcnt(6)
    v_xor_b32 v28, v56, v164
    v_xor_b32 v29, v57, v165
    v_xor_b32 v30, v58, v166
    v_xor_b32 v31, v59, v167
    v_or3_b32 v32, v32, v27, v28
    v_or3_b32 v32, v32, v29, v30
    v_bitop3_b32 v32, v32, v31, v39 bitop3:0xa8
    v_cmp_ne_u32 vcc, 0, v32
    s_or_b64 vcc, vcc, vcc
    s_cbranch_scc0 L_lgot
    s_waitcnt vmcnt(3)
    s_mov_b32 s39, -1
    s_branch L_pads9
    .p2align 10
L_pad9:
    s_setpc_b64 s[74:75]
L_pads9:
L_lpl:
    s_add_u32 s39, s39, 1
    s_cmp_ge_u32 s39, 24
    s_cbranch_scc1 L_lslow
    s_mov_b64 exec, s[50:51]
    global_load_dwordx4 v[24:27], v20, s[28:29] sc1
    s_mov_b32 exec_hi, s54
    global_load_dwordx4 v[28:31], v21, s[28:29] sc1
    s_mov_b64 exec, -1
    s_waitcnt vmcnt(1)
    v_xor_b32 v24, v12, v24
    v_xor_b32 v25, v13, v25
    v_xor_b32 v26, v14, v26
    v_xor_b32 v27, v15, v27
    v_or3_b32 v32, v24, v25, v26
    s_waitcnt vmcnt(0)
    v_xor_b32 v28, v56, v28
    v_xor_b32 v29, v57, v29
    v_xor_b32 v30, v58, v30
    v_xor_b32 v31, v59, v31
    v_or3_b32 v32, v32, v27, v28
    v_or3_b32 v32, v32, v29, v30
    v_bitop3_b32 v32, v32, v31, v39 bitop3:0xa8
    v_cmp_ne_u32 vcc, 0, v32
    s_or_b64 vcc, vcc, vcc
    s_cbranch_scc1 L_lpl
L_lgot:
    s_cmp_eq_u32 s42, 1
    s_cbranch_scc0 L_lgelu
    v_mov_b32_dpp v32, v24 row_newbcast:12 row_mask:0xf bank_mask:0xf
    v_mov_b32_dpp v33, v28 row_newbcast:12 row_mask:0xf bank_mask:0xf
    v_max_f32 v34, v32, v33
    v_max_f32 v35, v32, v33
    v_mov_b32_dpp v36, v25 row_newbcast:12 row_mask:0xf bank_mask:0xf
    v_mov_b32_dpp v37, v29 row_newbcast:12 row_mask:0xf bank_mask:0xf
    v_permlane32_swap_b32 v34, v35
    v_max_f32 v38, v34, v35
    v_max_f32 v35, v34, v35
    v_mul_f32 v32, s48, v32
    v_mul_f32 v33, s48, v33
    v_permlane16_swap_b32 v38, v35
    v_max_f32 v34, v38, v35
    v_fma_f32 v32, -v34, s48, v32
    v_fma_f32 v33, -v34, s48, v33
    v_exp_f32 v32, v32
    v_exp_f32 v33, v33
    v_mul_f32 v24, v24, v32
    v_mul_f32 v26, v26, v32
    v_mul_f32 v25, v25, v32
    v_mul_f32 v27, v27, v32
    v_fmac_f32 v24, v28, v33
    v_fmac_f32 v26, v30, v33
    v_fmac_f32 v25, v29, v33
    v_fmac_f32 v27, v31, v33
    v_permlane32_swap_b32 v24, v26
    v_mul_f32 v36, v36, v32
    v_permlane32_swap_b32 v25, v27
    v_add_f32 v24, v24, v26
    v_add_f32 v25, v25, v27
    v_fmac_f32 v36, v37, v33
    s_nop 0
    v_permlane16_swap_b32 v24, v25
    v_add_f32 v24, v24, v25
    v_cvt_pk_bf16_f32 v24, v24, v24
L_lmm:
    v_mov_b32 v37, v36
    s_nop 0
    v_and_b32_dpp v40, v24, v8 row_newbcast:0 row_mask:0xf bank_mask:0xf
    v_and_b32_dpp v41, v24, v9 row_newbcast:0 row_mask:0xf bank_mask:0xf
    v_and_b32_dpp v42, v24, v10 row_newbcast:0 row_mask:0xf bank_mask:0xf
    v_and_b32_dpp v43, v24, v11 row_newbcast:0 row_mask:0xf bank_mask:0xf
    v_and_b32_dpp v44, v24, v8 row_newbcast:1 row_mask:0xf bank_mask:0xf
    v_and_b32_dpp v45, v24, v9 row_newbcast:1 row_mask:0xf bank_mask:0xf
    v_and_b32_dpp v46, v24, v10 row_newbcast:1 row_mask:0xf bank_mask:0xf
    v_and_b32_dpp v47, v24, v11 row_newbcast:1 row_mask:0xf bank_mask:0xf
    v_mfma_f32_16x16x32_bf16 v[52:55], v[40:43], v[64:67], 0
    v_and_b32_dpp v48, v24, v8 row_newbcast:2 row_mask:0xf bank_mask:0xf
    v_and_b32_dpp v49, v24, v9 row_newbcast:2 row_mask:0xf bank_mask:0xf
    v_and_b32_dpp v50, v24, v10 row_newbcast:2 row_mask:0xf bank_mask:0xf
    v_and_b32_dpp v51, v24, v11 row_newbcast:2 row_mask:0xf bank_mask:0xf
    v_mfma_f32_16x16x32_bf16 v[52:55], v[44:47], v[68:71], v[52:55]
    v_and_b32_dpp v40, v24, v8 row_newbcast:3 row_mask:0xf bank_mask:0xf
    v_and_b32_dpp v41, v24, v9 row_newbcast:3 row_mask:0xf bank_mask:0xf
    v_and_b32_dpp v42, v24, v10 row_newbcast:3 row_mask:0xf bank_mask:0xf
    v_and_b32_dpp v43, v24, v11 row_newbcast:3 row_mask:0xf bank_mask:0xf
    v_mfma_f32_16x16x32_bf16 v[52:55], v[48:51], v[72:75], v[52:55]
    v_and_b32_dpp v44, v24, v8 row_newbcast:4 row_mask:0xf bank_mask:0xf
    v_and_b32_dpp v45, v24, v9 row_newbcast:4 row_mask:0xf bank_mask:0xf
    v_and_b32_dpp v46, v24, v10 row_newbcast:4 row_mask:0xf bank_mask:0xf
    v_and_b32_dpp v47, v24, v11 row_newbcast:4 row_mask:0xf bank_mask:0xf
    v_mfma_f32_16x16x32_bf16 v[52:55], v[40:43], v[76:79], v[52:55]
    v_and_b32_dpp v48, v24, v8 row_newbcast:5 row_mask:0xf bank_mask:0xf
    v_and_b32_dpp v49, v24, v9 row_newbcast:5 row_mask:0xf bank_mask:0xf
    v_and_b32_dpp v50, v24, v10 row_newbcast:5 row_mask:0xf bank_mask:0xf
    v_and_b32_dpp v51, v24, v11 row_newbcast:5 row_mask:0xf bank_mask:0xf
    v_mfma_f32_16x16x32_bf16 v[52:55], v[44:47], v[80:83], v[52:55]
    v_and_b32_dpp v40, v24, v8 row_newbcast:6 row_mask:0xf bank_mask:0xf
    v_and_b32_dpp v41, v24, v9 row_newbcast:6 row_mask:0xf bank_mask:0xf
    v_and_b32_dpp v42, v24, v10 row_newbcast:6 row_mask:0xf bank_mask:0xf
    v_and_b32_dpp v43, v24, v11 row_newbcast:6 row_mask:0xf bank_mask:0xf
    v_mfma_f32_16x16x32_bf16 v[52:55], v[48:51], v[84:87], v[52:55]
    v_and_b32_dpp v44, v24, v8 row_newbcast:7 row_mask:0xf bank_mask:0xf
    v_and_b32_dpp v45, v24, v9 row_newbcast:7 row_mask:0xf bank_mask:0xf
    v_and_b32_dpp v46, v24, v10 row_newbcast:7 row_mask:0xf bank_mask:0xf
    v_and_b32_dpp v47, v24, v11 row_newbcast:7 row_mask:0xf bank_mask:0xf
    s_waitcnt vmcnt(5)
    v_mfma_f32_16x16x32_bf16 v[52:55], v[40:43], v[88:91], v[52:55]
    v_and_b32_dpp v48, v24, v8 row_newbcast:8 row_mask:0xf bank_mask:0xf
    v_and_b32_dpp v49, v24, v9 row_newbcast:8 row_mask:0xf bank_mask:0xf
    v_and_b32_dpp v50, v24, v10 row_newbcast:8 row_mask:0xf bank_mask:0xf
    v_and_b32_dpp v51, v24, v11 row_newbcast:8 row_mask:0xf bank_mask:0xf
    s_waitcnt vmcnt(4)
    v_mfma_f32_16x16x32_bf16 v[52:55], v[44:47], v[92:95], v[52:55]
    v_and_b32_dpp v40, v24, v8 row_newbcast:9 row_mask:0xf bank_mask:0xf
    v_and_b32_dpp v41, v24, v9 row_newbcast:9 row_mask:0xf bank_mask:0xf
    v_and_b32_dpp v42, v24, v10 row_newbcast:9 row_mask:0xf bank_mask:0xf
    v_and_b32_dpp v43, v24, v11 row_newbcast:9 row_mask:0xf bank_mask:0xf
    s_waitcnt vmcnt(3)
    v_mfma_f32_16x16x32_bf16 v[52:55], v[48:51], v[96:99], v[52:55]
    v_and_b32_dpp v44, v24, v8 row_newbcast:10 row_mask:0xf bank_mask:0xf
    v_and_b32_dpp v45, v24, v9 row_newbcast:10 row_mask:0xf bank_mask:0xf
    v_and_b32_dpp v46, v24, v10 row_newbcast:10 row_mask:0xf bank_mask:0xf
    v_and_b32_dpp v47, v24, v11 row_newbcast:10 row_mask:0xf bank_mask:0xf
    s_waitcnt vmcnt(2)
    v_mfma_f32_16x16x32_bf16 v[52:55], v[40:43], v[100:103], v[52:55]
    v_and_b32_dpp v48, v24, v8 row_newbcast:11 row_mask:0xf bank_mask:0xf
    v_and_b32_dpp v49, v24, v9 row_newbcast:11 row_mask:0xf bank_mask:0xf
    v_and_b32_dpp v50, v24, v10 row_newbcast:11 row_mask:0xf bank_mask:0xf
    v_and_b32_dpp v51, v24, v11 row_newbcast:11 row_mask:0xf bank_mask:0xf
    s_waitcnt vmcnt(1)
    v_mfma_f32_16x16x32_bf16 v[52:55], v[44:47], v[104:107], v[52:55]
    s_waitcnt vmcnt(0)
    v_mfma_f32_16x16x32_bf16 v[52:55], v[48:51], v[108:111], v[52:55]
    v_permlane32_swap_b32 v36, v37
    v_add_f32 v38, v36, v37
    v_add_f32 v37, v36, v37
    s_mov_b32 exec_hi, 0
    s_nop 3
    ds_write_b128 v18, v[52:55] offset:13568
    s_mov_b64 exec, 1
    ds_add_rtn_u32 v60, v7, v6 offset:460
    s_mov_b64 exec, -1
    ds_read_b32 v122, v123 offset:464
    ds_read2st64_b32 v[64:65], v112 offset0:53 offset1:56
    ds_read2st64_b32 v[66:67], v112 offset0:59 offset1:62
    ds_read2st64_b32 v[68:69], v113 offset0:53 offset1:56
    ds_read2st64_b32 v[70:71], v113 offset0:59 offset1:62
    ds_read2st64_b32 v[72:73], v114 offset0:53 offset1:56
    ds_read2st64_b32 v[74:75], v114 offset0:59 offset1:62
    v_permlane16_swap_b32 v38, v37
    v_add_f32 v38, v38, v37
    v_rcp_f32 v38, v38
    s_waitcnt lgkmcnt(6)
    v_readfirstlane_b32 s37, v60
    s_cmp_eq_u32 s37, 3
    s_cbranch_scc0 L_fin
    v_mul_f32 v122, v122, v38
    v_cndmask_b32 v122, v7, v122, s[56:57]
    s_waitcnt lgkmcnt(4)
    v_pk_add_f32 v[64:65], v[64:65], v[66:67]
    v_add_f32 v64, v64, v65
    v_fma_f32 v64, v64, v122, v121
    global_atomic_add_f32 v65, v118, v64, s[28:29] offset:0 sc0
    s_waitcnt lgkmcnt(2)
    v_pk_add_f32 v[68:69], v[68:69], v[70:71]
    v_add_f32 v68, v68, v69
    v_fma_f32 v68, v68, v122, v121
    global_atomic_add_f32 v69, v118, v68, s[28:29] offset:512 sc0
    s_waitcnt lgkmcnt(0)
    v_pk_add_f32 v[72:73], v[72:73], v[74:75]
    v_add_f32 v72, v72, v73
    v_fma_f32 v72, v72, v122, v121
    s_mov_b64 exec, 0xffff
    global_atomic_add_f32 v73, v118, v72, s[28:29] offset:1024 sc0
    s_branch L_pads10
L_pad10:
    s_setpc_b64 s[74:75]
L_pads10:
    s_mov_b64 exec, -1
    s_waitcnt vmcnt(2)
    v_mov_b32_dpp v66, v65 row_newbcast:15 row_mask:0xf bank_mask:0xf
    v_add_f32 v64, v64, v65
    v_cmp_eq_f32 vcc, v66, v126
    v_cvt_pk_bf16_f32 v64, v64, v64
    s_and_b64 s[50:51], vcc, s[56:57]
    s_waitcnt vmcnt(1)
    v_mov_b32_dpp v70, v69 row_newbcast:15 row_mask:0xf bank_mask:0xf
    v_add_f32 v68, v68, v69
    v_cmp_eq_f32 vcc, v70, v126
    v_cvt_pk_bf16_f32 v68, v68, v68
    s_and_b64 s[52:53], vcc, s[56:57]
    s_waitcnt vmcnt(0)
    v_mov_b32_dpp v74, v73 row_newbcast:15 row_mask:0xf bank_mask:0xf
    v_add_f32 v72, v72, v73
    v_cmp_eq_f32 vcc, v74, v126
    v_cvt_pk_bf16_f32 v72, v72, v72
    s_mov_b64 exec, s[50:51]
    s_cbranch_execz L_ns0
    global_store_short v115, v64, s[24:25]
L_ns0:
    s_mov_b64 exec, s[52:53]
    s_cbranch_execz L_ns1
    global_store_short v116, v68, s[24:25]
L_ns1:
    s_and_b64 exec, vcc, s[58:59]
    s_cbranch_execz L_ns2
    global_store_short v117, v72, s[24:25]

L_ns2:
    s_endpgm
L_lgelu:
    v_mov_b32 v36, 0x3e800000
    v_permlane32_swap_b32 v24, v26
    v_permlane32_swap_b32 v25, v27
    v_permlane32_swap_b32 v28, v30
    v_permlane32_swap_b32 v29, v31
    v_add_f32 v24, v24, v26
    v_add_f32 v25, v25, v27
    v_add_f32 v28, v28, v30
    v_add_f32 v29, v29, v31
    v_permlane16_swap_b32 v24, v25
    s_nop 0
    v_permlane16_swap_b32 v28, v29
    v_add_f32 v24, v24, v25
    v_add_f32 v28, v28, v29
    v_cvt_pk_bf16_f32 v24, v24, v28
    v_lshlrev_b32 v25, 16, v24
    v_and_b32 v28, 0xffff0000, v24
    v_mul_f32 v26, v25, v25
    v_mul_f32 v26, v26, v25
    v_fma_f32 v26, v26, s49, v25
    v_mul_f32 v26, s43, v26
    v_exp_f32 v26, v26
    s_nop 0
    v_add_f32 v26, 1.0, v26
    v_rcp_f32 v26, v26
    s_nop 0
    v_mul_f32 v26, v26, v25
    v_cvt_pk_bf16_f32 v26, v26, v26
    v_lshlrev_b32 v26, 16, v26
    v_mul_f32 v24, v26, v28
    v_cvt_pk_bf16_f32 v24, v24, v24
    s_branch L_lmm
L_fh:
    s_mov_b64 exec, 1
    ds_add_u32 v7, v6 offset:4
    s_mov_b64 exec, -1
    s_cmp_eq_u32 s30, 3
    s_cbranch_scc0 L_tk
    s_lshl_b32 s37, s33, 13
    s_add_u32 s37, s37, 72704
    v_lshlrev_b32 v36, 4, v1
    v_add_u32 v36, s37, v36
    v_mov_b32 v15, s70
    v_and_b32 v12, 0xff, v15
    v_bfe_u32 v13, v15, 8, 8
    v_bfe_u32 v14, v15, 16, 8
    v_lshrrev_b32 v15, 24, v15
    v_mov_b32 v16, 0xffffff00
    s_mov_b64 exec, 0xff
    global_store_dwordx4 v36, v[12:15], s[28:29]
    s_mov_b64 exec, -1
    s_mov_b32 s39, 0
L_sp50:
    ds_read_b32 v22, v7 offset:8
    s_add_u32 s39, s39, 1
    s_waitcnt lgkmcnt(0)
    v_readfirstlane_b32 s61, v22
    s_cmp_ge_u32 s61, 4
    s_cbranch_scc1 L_spd51
    s_sleep 4
    s_cmp_lt_u32 s39, 0x9c400
    s_cbranch_scc1 L_sp50
L_spd51:
    s_branch L_hc
L_fin:
L_exit:
    s_endpgm
L_qslow:
    s_cmp_eq_u32 s30, 0
    s_cbranch_scc0 L_qt
    s_xor_b32 s37, s36, s70
    s_lshr_b32 s37, s37, 24
    v_xor_b32 v67, s37, v67
    s_mov_b32 exec_hi, 0xffff
    global_store_dwordx4 v19, v[64:67], s[64:65] sc1
L_qt:
    s_mov_b64 exec, -1
    s_xor_b32 s45, s36, s70
    s_lshr_b32 s45, s45, 24
    s_mov_b32 s39, 0
L_qsl:
    v_xor_b32 v15, s45, v15
    s_mov_b32 exec_hi, s54
    v_xor_b32 v59, s45, v59
    s_mov_b32 exec_hi, -1
    s_mov_b64 exec, s[50:51]
    global_load_dwordx4 v[24:27], v17, s[64:65] sc1
    s_mov_b32 exec_hi, s54
    global_load_dwordx4 v[28:31], v21, s[64:65] sc1
    s_mov_b64 exec, -1
    s_waitcnt vmcnt(1)
    v_xor_b32 v24, v12, v24
    v_xor_b32 v25, v13, v25
    v_xor_b32 v26, v14, v26
    v_xor_b32 v27, v15, v27
    v_or3_b32 v32, v24, v25, v26
    s_waitcnt vmcnt(0)
    v_xor_b32 v28, v56, v28
    v_xor_b32 v29, v57, v29
    v_xor_b32 v30, v58, v30
    v_xor_b32 v31, v59, v31
    v_or3_b32 v32, v32, v27, v28
    v_or3_b32 v32, v32, v29, v30
    v_bitop3_b32 v32, v32, v31, v39 bitop3:0xa8
    v_cmp_ne_u32 vcc, 0, v32
    s_or_b64 vcc, vcc, vcc
    s_cbranch_scc0 L_qgot
    v_xor_b32 v15, s45, v15
    s_mov_b32 exec_hi, s54
    v_xor_b32 v59, s45, v59
    s_mov_b32 exec_hi, -1
    s_mov_b64 exec, s[50:51]
    global_load_dwordx4 v[24:27], v17, s[28:29] sc1
    s_mov_b32 exec_hi, s54
    global_load_dwordx4 v[28:31], v21, s[28:29] sc1
    s_mov_b64 exec, -1
    s_waitcnt vmcnt(1)
    v_xor_b32 v24, v12, v24
    v_xor_b32 v25, v13, v25
    v_xor_b32 v26, v14, v26
    v_xor_b32 v27, v15, v27
    v_or3_b32 v32, v24, v25, v26
    s_waitcnt vmcnt(0)
    v_xor_b32 v28, v56, v28
    v_xor_b32 v29, v57, v29
    v_xor_b32 v30, v58, v30
    v_xor_b32 v31, v59, v31
    v_or3_b32 v32, v32, v27, v28
    v_or3_b32 v32, v32, v29, v30
    v_bitop3_b32 v32, v32, v31, v39 bitop3:0xa8
    v_cmp_ne_u32 vcc, 0, v32
    s_or_b64 vcc, vcc, vcc
    s_cbranch_scc0 L_qgot
    s_add_u32 s39, s39, 1
    s_cmp_lt_u32 s39, 40000
    s_cbranch_scc1 L_qsl
    s_branch L_qgot
L_lslow:
    s_mov_b64 exec, -1
    s_xor_b32 s45, s36, s70
    s_lshr_b32 s45, s45, 24
    s_mov_b32 s39, 0
L_lsl:
    v_xor_b32 v15, s45, v15
    s_mov_b32 exec_hi, s54
    v_xor_b32 v59, s45, v59
    s_mov_b32 exec_hi, -1
    s_mov_b64 exec, s[50:51]
    global_load_dwordx4 v[24:27], v20, s[64:65] sc1
    s_mov_b32 exec_hi, s54
    global_load_dwordx4 v[28:31], v21, s[64:65] sc1
    s_mov_b64 exec, -1
    s_waitcnt vmcnt(1)
    v_xor_b32 v24, v12, v24
    v_xor_b32 v25, v13, v25
    v_xor_b32 v26, v14, v26
    v_xor_b32 v27, v15, v27
    v_or3_b32 v32, v24, v25, v26
    s_waitcnt vmcnt(0)
    v_xor_b32 v28, v56, v28
    v_xor_b32 v29, v57, v29
    v_xor_b32 v30, v58, v30
    v_xor_b32 v31, v59, v31
    v_or3_b32 v32, v32, v27, v28
    v_or3_b32 v32, v32, v29, v30
    v_bitop3_b32 v32, v32, v31, v39 bitop3:0xa8
    v_cmp_ne_u32 vcc, 0, v32
    s_or_b64 vcc, vcc, vcc
    s_cbranch_scc0 L_lgot
    v_xor_b32 v15, s45, v15
    s_mov_b32 exec_hi, s54
    v_xor_b32 v59, s45, v59
    s_mov_b32 exec_hi, -1
    s_mov_b64 exec, s[50:51]
    global_load_dwordx4 v[24:27], v20, s[28:29] sc1
    s_mov_b32 exec_hi, s54
    global_load_dwordx4 v[28:31], v21, s[28:29] sc1
    s_mov_b64 exec, -1
    s_waitcnt vmcnt(1)
    v_xor_b32 v24, v12, v24
    v_xor_b32 v25, v13, v25
    v_xor_b32 v26, v14, v26
    v_xor_b32 v27, v15, v27
    v_or3_b32 v32, v24, v25, v26
    s_waitcnt vmcnt(0)
    v_xor_b32 v28, v56, v28
    v_xor_b32 v29, v57, v29
    v_xor_b32 v30, v58, v30
    v_xor_b32 v31, v59, v31
    v_or3_b32 v32, v32, v27, v28
    v_or3_b32 v32, v32, v29, v30
    v_bitop3_b32 v32, v32, v31, v39 bitop3:0xa8
    v_cmp_ne_u32 vcc, 0, v32
    s_or_b64 vcc, vcc, vcc
    s_cbranch_scc0 L_lgot
    s_add_u32 s39, s39, 1
    s_cmp_lt_u32 s39, 40000
    s_cbranch_scc1 L_lsl
    s_branch L_lgot
    .fill 64, 4, 0xbf800000

.section .rodata,"a"
.p2align 6
.amdhsa_kernel gated_mix__sliding_block_cached__glu_gated_geglu__decode_kernel
  .amdhsa_next_free_vgpr 224
  .amdhsa_next_free_sgpr 102
  .amdhsa_accum_offset 224
  .amdhsa_group_segment_fixed_size 0
  .amdhsa_kernarg_size 104
  .amdhsa_user_sgpr_count 2
  .amdhsa_user_sgpr_kernarg_segment_ptr 1
  .amdhsa_system_sgpr_workgroup_id_x 1
.end_amdhsa_kernel
```
